```python
import torch

def _softmax(x, axis=-1):
    return torch.softmax(x, dim=axis)
def _gelu(x):
    return torch.nn.functional.gelu(x, approximate="tanh")
def _silu(x):
    return torch.nn.functional.silu(x)
def _sigmoid(x):
    return torch.sigmoid(x)
def _layernorm(x, axis=-1, eps=1e-5):
    m = x.mean(dim=axis, keepdim=True)
    v = x.var(dim=axis, keepdim=True, unbiased=False)
    return (x - m) / torch.sqrt(v + eps)
def _scatter_add(tgt, idx, src, axis=0):
    return tgt.clone().index_add_(axis, idx, src)
def _segment_sum(src, seg, n):
    out = torch.zeros((n,) + src.shape[1:], dtype=src.dtype)
    return out.index_add_(0, seg, src)
def _pad(x, pw):
    flat = tuple(v for pair in reversed(pw) for v in pair)
    return torch.nn.functional.pad(x, flat)

kernel_name = 'parallel_sum__sliding_block__dense_activation_silu__prompt'

def setup_inputs():

    _w = (lambda a: (lambda t: t.to(torch.bfloat16) if t.is_floating_point() else t)(torch.as_tensor(a)))
    def _A_setup():
        B, S, D = 1, 2048, 512
        return {
            "x": _w((lambda *s: torch.randn(*s, dtype=torch.bfloat16) * 0.05)(B, S, D)),
            "wqkv": _w((lambda *s: torch.randn(*s, dtype=torch.bfloat16) * 0.05)(D, 3 * D)),
            "wo": _w((lambda *s: torch.randn(*s, dtype=torch.bfloat16) * 0.05)(D, D)),
        }
    _A_in = _A_setup()

    def _B_setup():
        B, S, D, F = 1, 2048, 512, 1376
        return {
            "x": _w((lambda *s: torch.randn(*s, dtype=torch.bfloat16) * 0.05)(B, S, D)),
            "w1": _w((lambda *s: torch.randn(*s, dtype=torch.bfloat16) * 0.8)(D, F) * (D ** -0.5)),
            "w2": _w((lambda *s: torch.randn(*s, dtype=torch.bfloat16) * 0.8)(F, D) * (F ** -0.5)),
        }
    _B_in = _B_setup()

    return {
        "A_x": _A_in["x"],
        "A_wqkv": _A_in["wqkv"],
        "A_wo": _A_in["wo"],
        "B_x": _B_in["x"],
        "B_w1": _B_in["w1"],
        "B_w2": _B_in["w2"],
    }

def reference(A_x, A_wqkv, A_wo, B_x, B_w1, B_w2):
    def _A_ref(x, wqkv, wo):
        B, S, D = x.shape
        H = 32; Dh = D // H; W = 256
        qkv = (lambda x, *d: x.permute(*d))((x @ wqkv).reshape(B, S, 3, H, Dh), 2, 0, 3, 1, 4)
        q, k, v = qkv[0], qkv[1], qkv[2]
        scores = torch.einsum("bhqd,bhkd->bhqk", q, k) * (Dh ** -0.5)
        idx = torch.arange(S)
        mask = (idx[:, None] - idx[None, :] >= 0) & (idx[:, None] - idx[None, :] < W)
        scores = torch.where(mask[None, None], scores, -1e9)
        p = _softmax(scores, axis=-1)
        o = torch.einsum("bhqk,bhkd->bhqd", p, v)
        return (lambda x, *d: x.permute(*d))(o, 0, 2, 1, 3).reshape(B, S, D) @ wo

    def _B_ref(x, w1, w2):
        h = torch.einsum("bsd,df->bsf", x, w1)
        h = _silu(h)
        out = torch.einsum("bsf,fd->bsd", h, w2)
        return out

    x = A_x
    xn = _layernorm(x, axis=-1)
    return x + _A_ref(xn, A_wqkv, A_wo) + _B_ref(xn, B_w1, B_w2)
```

```asm
; @launch grid=(256,1,1) block=(512,1,1) lds=163840
.amdgcn_target "amdgcn-amd-amdhsa--gfx950"
.text
.globl parallel_sum__sliding_block__dense_activation_silu__prompt_kernel
.p2align 8
.type parallel_sum__sliding_block__dense_activation_silu__prompt_kernel,@function
parallel_sum__sliding_block__dense_activation_silu__prompt_kernel:
    s_cmp_ge_u32 s2, 256
    s_cbranch_scc1 Lend
    s_load_dwordx2 s[36:37], s[0:1], 56
    s_load_dwordx2 s[16:17], s[0:1], 32
    s_load_dwordx2 s[20:21], s[0:1], 40
    s_load_dwordx2 s[24:25], s[0:1], 16
    s_load_dwordx2 s[28:29], s[0:1], 48
    s_load_dwordx2 s[32:33], s[0:1], 64
    s_load_dwordx2 s[8:9], s[0:1], 0
    s_mov_b32 s10, 2097152
    s_mov_b32 s11, 0x00020000
    s_load_dwordx2 s[12:13], s[0:1], 8
    s_mov_b32 s14, 1572864
    s_mov_b32 s15, 0x00020000
    s_memrealtime s[56:57]
    v_lshrrev_b32 v1, 6, v0
    v_and_b32 v0, 63, v0
    v_readfirstlane_b32 s42, v1
    s_and_b32 s40, s2, 6
    s_lshl_b32 s40, s40, 1
    s_bfe_u32 s47, s2, 0x20003
    s_add_u32 s40, s40, s47
    s_and_b32 s41, s2, 1
    s_lshl_b32 s41, s41, 3
    s_lshr_b32 s48, s2, 5
    s_add_u32 s41, s41, s48
    s_lshl_b32 s100, s47, 1
    s_add_u32 s100, s100, s41
    s_and_b32 s43, s42, 3
    s_lshr_b32 s44, s42, 2
    s_lshl_b32 s45, s42, 11
    s_lshl_b32 s46, s43, 10
    s_mov_b32 s58, 0x3f803f80
    s_lshl_b32 s59, s40, 2
    s_add_u32 s59, s59, s43
    s_lshr_b32 s47, s40, 2
    s_add_u32 s100, s100, s47
    v_lshrrev_b32 v10, 3, v0
    v_lshrrev_b32 v11, 4, v0
    v_and_b32 v12, 7, v0
    v_xor_b32 v12, v12, v11
    v_lshlrev_b32 v12, 4, v12
    v_lshl_add_u32 v1, v10, 10, v12
    s_lshl_b32 s47, s40, 17
    s_lshl_b32 s48, s42, 14
    s_add_u32 s47, s47, s48
    v_add_u32 v1, s47, v1
    v_xor_b32 v2, 64, v1
    v_add_u32 v2, 8192, v2
    v_lshrrev_b32 v10, 2, v0
    v_and_b32 v12, 3, v0
    v_lshlrev_b32 v12, 4, v12
    s_lshl_b32 s47, s43, 4
    v_add_u32 v10, s47, v10
    v_mul_u32_u24 v3, 3072, v10
    s_lshl_b32 s47, s41, 6
    v_add3_u32 v3, v3, v12, s47
    s_waitcnt lgkmcnt(0)
    s_add_u32 s48, s100, 0
    s_and_b32 s48, s48, 7
    s_mul_i32 s96, s48, 196608
    s_lshl_b32 s97, s48, 7
    s_add_u32 m0, s45, 57344
    s_nop 0
    buffer_load_dwordx4 v1, s[8:11], s97 offen lds
    s_add_u32 m0, s45, 58368
    s_nop 0
    buffer_load_dwordx4 v2, s[8:11], s97 offen lds
    s_cmp_eq_u32 s44, 1
    s_cselect_b32 s47, 0, 1024
    s_cselect_b32 s3, 8192, 0
    s_add_u32 s48, s96, s47
    s_add_u32 s3, s3, s46
    s_add_u32 m0, s3, 73728
    s_nop 0
    buffer_load_dwordx4 v3, s[12:15], s48 offen lds
    s_mov_b32 s38, 256
    s_mov_b32 s39, 0x00020000
    s_mov_b32 s18, 1409024
    s_mov_b32 s19, 0x00020000
    s_mov_b32 s22, 1409024
    s_mov_b32 s23, 0x00020000
    s_mov_b32 s26, 524288
    s_mov_b32 s27, 0x00020000
    s_mov_b32 s30, 2097152
    s_mov_b32 s31, 0x00020000
    s_mov_b32 s34, 16777216
    s_mov_b32 s35, 0x00020000
    s_cmp_eq_u32 s44, 1
    s_cbranch_scc1 Lnh1
    s_add_u32 s48, s96, 2048
    s_add_u32 m0, s46, 77824
    s_nop 0
    buffer_load_dwordx4 v3, s[12:15], s48 offen lds
    s_add_u32 s48, s100, 1
    s_and_b32 s48, s48, 7
    s_mul_i32 s96, s48, 196608
    s_lshl_b32 s97, s48, 7
    s_add_u32 m0, s45, 86016
    s_nop 0
    buffer_load_dwordx4 v1, s[8:11], s97 offen lds
    s_add_u32 m0, s45, 87040
    s_nop 0
    buffer_load_dwordx4 v2, s[8:11], s97 offen lds
    s_add_u32 s48, s96, 1024
    s_add_u32 m0, s46, 102400
    s_nop 0
    buffer_load_dwordx4 v3, s[12:15], s48 offen lds
    s_add_u32 s48, s96, 2048
    s_add_u32 m0, s46, 106496
    s_nop 0
    buffer_load_dwordx4 v3, s[12:15], s48 offen lds
    v_and_b32 v10, 31, v0
    v_lshrrev_b32 v11, 5, v0
    v_bfe_u32 v12, v0, 1, 3
    v_xor_b32 v12, v12, v11
    v_lshlrev_b32 v12, 4, v12
    v_lshl_add_u32 v5, v10, 7, v12
    s_lshl_b32 s47, s43, 12
    v_add_u32 v5, s47, v5
    s_lshl_b32 s47, s43, 5
    v_xor_b32 v5, s47, v5
    s_xor_b32 s5, s46, 1024
    s_xor_b32 s6, s46, 2048
    s_xor_b32 s7, s46, 3072
    s_mov_b32 s4, s46
    v_lshrrev_b32 v13, 2, v0
    v_xor_b32 v13, v13, v0
    v_and_b32 v13, 4, v13
    v_and_b32 v14, 3, v0
    v_or_b32 v13, v13, v14
    v_cmp_eq_u32 vcc, 0, v13
    v_mov_b32 v14, s58
    s_nop 0
    v_cndmask_b32 v240, 0, v14, vcc
    v_cndmask_b32 v241, 0, v14, vcc
    v_cndmask_b32 v242, 0, v14, vcc
    v_cndmask_b32 v243, 0, v14, vcc
    v_xor_b32 v6, 32, v5
    v_xor_b32 v7, 64, v5
    v_xor_b32 v8, 0x60, v5
    v_bfe_u32 v12, v0, 2, 2
    v_lshlrev_b32 v22, 6, v12
    v_bfe_u32 v12, v0, 4, 1
    v_lshl_add_u32 v22, v12, 5, v22
    v_and_b32 v12, 3, v0
    v_lshl_add_u32 v22, v12, 3, v22
    v_lshl_add_u32 v9, v11, 9, v22
    v_lshlrev_b32 v21, 4, v0
    v_mov_b32 v23, 0
    v_lshlrev_b32 v12, 4, v11
    s_lshl_b32 s62, s59, 8
    s_lshl_b32 s47, s41, 4
    s_add_u32 s62, s62, s47
    s_lshl_b32 s47, s44, 3
    s_add_u32 s62, s62, s47
    s_or_b32 s47, s2, s42
    s_cmp_lg_u32 s47, 0
    s_cbranch_scc1 Lnn
    s_or_b32 s56, s56, 1
    v_mov_b32 v24, s56
    v_mov_b32 v25, s57
    s_mov_b64 exec, 1
    buffer_store_dwordx2 v[24:25], v0, s[36:39], 0 offen sc1
    s_mov_b64 exec, -1
Lnn:
    v_add_u32 v224, 57344, v5
    v_add_u32 v225, 57344, v6
    v_add_u32 v226, 57344, v7
    v_add_u32 v227, 57344, v8
    s_add_u32 s47, s4, 73728
    v_add_u32 v10, s47, v9
    s_add_u32 s47, s5, 73728
    v_add_u32 v11, s47, v9
    s_add_u32 s47, s6, 73728
    v_add_u32 v13, s47, v9
    s_add_u32 s47, s7, 73728
    v_add_u32 v14, s47, v9
    s_waitcnt vmcnt(4)
    s_barrier
    ds_read_b128 v[32:35], v224
    ds_read_b64_tr_b16 v[192:193], v10 offset:0
    ds_read_b64_tr_b16 v[194:195], v10 offset:256
    ds_read_b64_tr_b16 v[196:197], v10 offset:4096
    ds_read_b64_tr_b16 v[198:199], v10 offset:4352
    s_add_u32 s48, s100, 2
    s_and_b32 s48, s48, 7
    s_mul_i32 s96, s48, 196608
    s_lshl_b32 s97, s48, 7
    s_add_u32 m0, s45, 114688
    s_nop 0
    buffer_load_dwordx4 v1, s[8:11], s97 offen lds
    s_add_u32 m0, s45, 115712
    s_nop 0
    buffer_load_dwordx4 v2, s[8:11], s97 offen lds
    ds_read_b128 v[36:39], v225
    ds_read_b64_tr_b16 v[200:201], v11 offset:0
    ds_read_b64_tr_b16 v[202:203], v11 offset:256
    ds_read_b64_tr_b16 v[204:205], v11 offset:4096
    ds_read_b64_tr_b16 v[206:207], v11 offset:4352
    s_add_u32 s48, s96, 1024
    s_add_u32 m0, s46, 131072
    s_nop 0
    buffer_load_dwordx4 v3, s[12:15], s48 offen lds
    s_add_u32 s48, s96, 2048
    s_add_u32 m0, s46, 135168
    s_nop 0
    buffer_load_dwordx4 v3, s[12:15], s48 offen lds
    ds_read_b128 v[40:43], v226
    ds_read_b64_tr_b16 v[208:209], v13 offset:0
    ds_read_b64_tr_b16 v[210:211], v13 offset:256
    ds_read_b64_tr_b16 v[212:213], v13 offset:4096
    ds_read_b64_tr_b16 v[214:215], v13 offset:4352
    s_add_u32 s48, s100, 3
    s_and_b32 s48, s48, 7
    s_mul_i32 s96, s48, 196608
    s_lshl_b32 s97, s48, 7
    s_add_u32 m0, s45, 0
    s_nop 0
    buffer_load_dwordx4 v1, s[8:11], s97 offen lds
    s_add_u32 m0, s45, 1024
    s_nop 0
    buffer_load_dwordx4 v2, s[8:11], s97 offen lds
    s_waitcnt lgkmcnt(10)
    ds_read_b128 v[44:47], v227
    ds_read_b64_tr_b16 v[216:217], v14 offset:0
    ds_read_b64_tr_b16 v[218:219], v14 offset:256
    ds_read_b64_tr_b16 v[220:221], v14 offset:4096
    ds_read_b64_tr_b16 v[222:223], v14 offset:4352
    s_add_u32 s48, s96, 1024
    s_add_u32 m0, s46, 16384
    s_nop 0
    buffer_load_dwordx4 v3, s[12:15], s48 offen lds
    s_add_u32 s48, s96, 2048
    s_add_u32 m0, s46, 20480
    s_nop 0
    buffer_load_dwordx4 v3, s[12:15], s48 offen lds
    v_and_b32 v10, 31, v0
    v_lshrrev_b32 v11, 2, v12
    v_sub_u32 v10, v10, v11
    v_cmp_gt_i32 s[64:65], 0, v10
    v_cmp_gt_i32 s[66:67], 1, v10
    v_cmp_gt_i32 s[68:69], 2, v10
    v_cmp_gt_i32 s[70:71], 3, v10
    v_cmp_gt_i32 s[72:73], 8, v10
    v_cmp_gt_i32 s[74:75], 9, v10
    v_cmp_gt_i32 s[76:77], 10, v10
    v_cmp_gt_i32 s[78:79], 11, v10
    v_cmp_gt_i32 s[80:81], 16, v10
    v_cmp_gt_i32 s[82:83], 17, v10
    v_cmp_gt_i32 s[84:85], 18, v10
    v_cmp_gt_i32 s[86:87], 19, v10
    v_cmp_gt_i32 s[88:89], 24, v10
    v_cmp_gt_i32 s[90:91], 25, v10
    v_cmp_gt_i32 s[92:93], 26, v10
    v_cmp_gt_i32 s[94:95], 27, v10
    v_mov_b32 v13, 0xffff
    v_mov_b32 v14, 0xffff0000
    v_cndmask_b32 v232, 0, v13, s[64:65]
    v_cndmask_b32 v11, 0, v14, s[66:67]
    v_or_b32 v232, v232, v11
    v_cndmask_b32 v233, 0, v13, s[68:69]
    v_cndmask_b32 v11, 0, v14, s[70:71]
    v_or_b32 v233, v233, v11
    v_cndmask_b32 v234, 0, v13, s[72:73]
    v_cndmask_b32 v11, 0, v14, s[74:75]
    v_or_b32 v234, v234, v11
    v_cndmask_b32 v235, 0, v13, s[76:77]
    v_cndmask_b32 v11, 0, v14, s[78:79]
    v_or_b32 v235, v235, v11
    v_cndmask_b32 v236, 0, v13, s[80:81]
    v_cndmask_b32 v11, 0, v14, s[82:83]
    v_or_b32 v236, v236, v11
    v_cndmask_b32 v237, 0, v13, s[84:85]
    v_cndmask_b32 v11, 0, v14, s[86:87]
    v_or_b32 v237, v237, v11
    v_cndmask_b32 v238, 0, v13, s[88:89]
    v_cndmask_b32 v11, 0, v14, s[90:91]
    v_or_b32 v238, v238, v11
    v_cndmask_b32 v239, 0, v13, s[92:93]
    v_cndmask_b32 v11, 0, v14, s[94:95]
    v_or_b32 v239, v239, v11
    v_add_u32 v224, 86016, v5
    v_add_u32 v225, 86016, v6
    v_add_u32 v226, 86016, v7
    v_add_u32 v227, 86016, v8
    s_add_u32 s47, s4, 102400
    v_add_u32 v10, s47, v9
    s_add_u32 s47, s5, 102400
    v_add_u32 v11, s47, v9
    s_add_u32 s47, s6, 102400
    v_add_u32 v13, s47, v9
    s_add_u32 s47, s7, 102400
    v_add_u32 v14, s47, v9
    s_waitcnt vmcnt(8)
    s_barrier
    s_waitcnt lgkmcnt(10)
    v_mfma_f32_32x32x16_bf16 v[160:175], v[192:195], v[32:35], 0
    v_mfma_f32_32x32x16_bf16 v[176:191], v[32:35], v[196:199], 0
    ds_read_b128 v[48:51], v224
    ds_read_b64_tr_b16 v[192:193], v10 offset:0
    ds_read_b64_tr_b16 v[194:195], v10 offset:256
    ds_read_b64_tr_b16 v[196:197], v10 offset:4096
    ds_read_b64_tr_b16 v[198:199], v10 offset:4352
    s_add_u32 s48, s100, 4
    s_and_b32 s48, s48, 7
    s_mul_i32 s96, s48, 196608
    s_lshl_b32 s97, s48, 7
    s_add_u32 m0, s45, 28672
    s_nop 0
    buffer_load_dwordx4 v1, s[8:11], s97 offen lds
    s_waitcnt lgkmcnt(10)
    v_mfma_f32_32x32x16_bf16 v[160:175], v[200:203], v[36:39], v[160:175]
    v_mfma_f32_32x32x16_bf16 v[176:191], v[36:39], v[204:207], v[176:191]
    ds_read_b128 v[52:55], v225
    ds_read_b64_tr_b16 v[200:201], v11 offset:0
    ds_read_b64_tr_b16 v[202:203], v11 offset:256
    ds_read_b64_tr_b16 v[204:205], v11 offset:4096
    ds_read_b64_tr_b16 v[206:207], v11 offset:4352
    s_add_u32 m0, s45, 29696
    s_nop 0
    buffer_load_dwordx4 v2, s[8:11], s97 offen lds
    s_waitcnt lgkmcnt(10)
    v_mfma_f32_32x32x16_bf16 v[160:175], v[208:211], v[40:43], v[160:175]
    v_mfma_f32_32x32x16_bf16 v[176:191], v[40:43], v[212:215], v[176:191]
    ds_read_b128 v[56:59], v226
    ds_read_b64_tr_b16 v[208:209], v13 offset:0
    ds_read_b64_tr_b16 v[210:211], v13 offset:256
    ds_read_b64_tr_b16 v[212:213], v13 offset:4096
    ds_read_b64_tr_b16 v[214:215], v13 offset:4352
    s_add_u32 s48, s96, 1024
    s_add_u32 m0, s46, 45056
    s_nop 0
    buffer_load_dwordx4 v3, s[12:15], s48 offen lds
    s_waitcnt lgkmcnt(10)
    v_mfma_f32_32x32x16_bf16 v[160:175], v[216:219], v[44:47], v[160:175]
    v_mfma_f32_32x32x16_bf16 v[176:191], v[44:47], v[220:223], v[176:191]
    v_mfma_f32_16x16x32_bf16 v[248:251], v[240:243], v[216:219], 0
    v_mfma_f32_16x16x32_bf16 v[28:31], v[240:243], v[220:223], 0
    ds_read_b128 v[60:63], v227
    ds_read_b64_tr_b16 v[216:217], v14 offset:0
    ds_read_b64_tr_b16 v[218:219], v14 offset:256
    ds_read_b64_tr_b16 v[220:221], v14 offset:4096
    ds_read_b64_tr_b16 v[222:223], v14 offset:4352
    s_add_u32 s48, s96, 2048
    s_add_u32 m0, s46, 49152
    s_nop 0
    buffer_load_dwordx4 v3, s[12:15], s48 offen lds
    v_add_u32 v224, 114688, v5
    v_add_u32 v225, 114688, v6
    v_add_u32 v226, 114688, v7
    v_add_u32 v227, 114688, v8
    s_add_u32 s47, s4, 131072
    v_add_u32 v10, s47, v9
    s_add_u32 s47, s5, 131072
    v_add_u32 v11, s47, v9
    s_add_u32 s47, s6, 131072
    v_add_u32 v13, s47, v9
    s_add_u32 s47, s7, 131072
    v_add_u32 v14, s47, v9
    s_waitcnt vmcnt(8)
    s_barrier
    s_waitcnt lgkmcnt(10)
    v_mfma_f32_32x32x16_bf16 v[160:175], v[192:195], v[48:51], v[160:175]
    v_mfma_f32_32x32x16_bf16 v[176:191], v[48:51], v[196:199], v[176:191]
    ds_read_b128 v[64:67], v224
    ds_read_b64_tr_b16 v[192:193], v10 offset:0
    ds_read_b64_tr_b16 v[194:195], v10 offset:256
    ds_read_b64_tr_b16 v[196:197], v10 offset:4096
    ds_read_b64_tr_b16 v[198:199], v10 offset:4352
    s_add_u32 s48, s100, 5
    s_and_b32 s48, s48, 7
    s_mul_i32 s96, s48, 196608
    s_lshl_b32 s97, s48, 7
    s_add_u32 m0, s45, 57344
    s_nop 0
    buffer_load_dwordx4 v1, s[8:11], s97 offen lds
    s_waitcnt lgkmcnt(10)
    v_mfma_f32_32x32x16_bf16 v[160:175], v[200:203], v[52:55], v[160:175]
    v_mfma_f32_32x32x16_bf16 v[176:191], v[52:55], v[204:207], v[176:191]
    ds_read_b128 v[68:71], v225
    ds_read_b64_tr_b16 v[200:201], v11 offset:0
    ds_read_b64_tr_b16 v[202:203], v11 offset:256
    ds_read_b64_tr_b16 v[204:205], v11 offset:4096
    ds_read_b64_tr_b16 v[206:207], v11 offset:4352
    s_add_u32 m0, s45, 58368
    s_nop 0
    buffer_load_dwordx4 v2, s[8:11], s97 offen lds
    s_waitcnt lgkmcnt(10)
    v_mfma_f32_32x32x16_bf16 v[160:175], v[208:211], v[56:59], v[160:175]
    v_mfma_f32_32x32x16_bf16 v[176:191], v[56:59], v[212:215], v[176:191]
    ds_read_b128 v[72:75], v226
    ds_read_b64_tr_b16 v[208:209], v13 offset:0
    ds_read_b64_tr_b16 v[210:211], v13 offset:256
    ds_read_b64_tr_b16 v[212:213], v13 offset:4096
    ds_read_b64_tr_b16 v[214:215], v13 offset:4352
    s_add_u32 s48, s96, 1024
    s_add_u32 m0, s46, 73728
    s_nop 0
    buffer_load_dwordx4 v3, s[12:15], s48 offen lds
    s_waitcnt lgkmcnt(10)
    v_mfma_f32_32x32x16_bf16 v[160:175], v[216:219], v[60:63], v[160:175]
    v_mfma_f32_32x32x16_bf16 v[176:191], v[60:63], v[220:223], v[176:191]
    v_mfma_f32_16x16x32_bf16 v[248:251], v[240:243], v[216:219], v[248:251]
    v_mfma_f32_16x16x32_bf16 v[28:31], v[240:243], v[220:223], v[28:31]
    ds_read_b128 v[76:79], v227
    ds_read_b64_tr_b16 v[216:217], v14 offset:0
    ds_read_b64_tr_b16 v[218:219], v14 offset:256
    ds_read_b64_tr_b16 v[220:221], v14 offset:4096
    ds_read_b64_tr_b16 v[222:223], v14 offset:4352
    s_add_u32 s48, s96, 2048
    s_add_u32 m0, s46, 77824
    s_nop 0
    buffer_load_dwordx4 v3, s[12:15], s48 offen lds
    v_add_u32 v224, 0, v5
    v_add_u32 v225, 0, v6
    v_add_u32 v226, 0, v7
    v_add_u32 v227, 0, v8
    s_add_u32 s47, s4, 16384
    v_add_u32 v10, s47, v9
    s_add_u32 s47, s5, 16384
    v_add_u32 v11, s47, v9
    s_add_u32 s47, s6, 16384
    v_add_u32 v13, s47, v9
    s_add_u32 s47, s7, 16384
    v_add_u32 v14, s47, v9
    s_waitcnt vmcnt(8)
    s_barrier
    s_waitcnt lgkmcnt(10)
    v_mfma_f32_32x32x16_bf16 v[160:175], v[192:195], v[64:67], v[160:175]
    v_mfma_f32_32x32x16_bf16 v[176:191], v[64:67], v[196:199], v[176:191]
    ds_read_b128 v[80:83], v224
    ds_read_b64_tr_b16 v[192:193], v10 offset:0
    ds_read_b64_tr_b16 v[194:195], v10 offset:256
    ds_read_b64_tr_b16 v[196:197], v10 offset:4096
    ds_read_b64_tr_b16 v[198:199], v10 offset:4352
    s_add_u32 s48, s100, 6
    s_and_b32 s48, s48, 7
    s_mul_i32 s96, s48, 196608
    s_lshl_b32 s97, s48, 7
    s_add_u32 m0, s45, 86016
    s_nop 0
    buffer_load_dwordx4 v1, s[8:11], s97 offen lds
    s_waitcnt lgkmcnt(10)
    v_mfma_f32_32x32x16_bf16 v[160:175], v[200:203], v[68:71], v[160:175]
    v_mfma_f32_32x32x16_bf16 v[176:191], v[68:71], v[204:207], v[176:191]
    ds_read_b128 v[84:87], v225
    ds_read_b64_tr_b16 v[200:201], v11 offset:0
    ds_read_b64_tr_b16 v[202:203], v11 offset:256
    ds_read_b64_tr_b16 v[204:205], v11 offset:4096
    ds_read_b64_tr_b16 v[206:207], v11 offset:4352
    s_add_u32 m0, s45, 87040
    s_nop 0
    buffer_load_dwordx4 v2, s[8:11], s97 offen lds
    s_waitcnt lgkmcnt(10)
    v_mfma_f32_32x32x16_bf16 v[160:175], v[208:211], v[72:75], v[160:175]
    v_mfma_f32_32x32x16_bf16 v[176:191], v[72:75], v[212:215], v[176:191]
    ds_read_b128 v[88:91], v226
    ds_read_b64_tr_b16 v[208:209], v13 offset:0
    ds_read_b64_tr_b16 v[210:211], v13 offset:256
    ds_read_b64_tr_b16 v[212:213], v13 offset:4096
    ds_read_b64_tr_b16 v[214:215], v13 offset:4352
    s_add_u32 s48, s96, 1024
    s_add_u32 m0, s46, 102400
    s_nop 0
    buffer_load_dwordx4 v3, s[12:15], s48 offen lds
    s_waitcnt lgkmcnt(10)
    v_mfma_f32_32x32x16_bf16 v[160:175], v[216:219], v[76:79], v[160:175]
    v_mfma_f32_32x32x16_bf16 v[176:191], v[76:79], v[220:223], v[176:191]
    v_mfma_f32_16x16x32_bf16 v[248:251], v[240:243], v[216:219], v[248:251]
    v_mfma_f32_16x16x32_bf16 v[28:31], v[240:243], v[220:223], v[28:31]
    ds_read_b128 v[92:95], v227
    ds_read_b64_tr_b16 v[216:217], v14 offset:0
    ds_read_b64_tr_b16 v[218:219], v14 offset:256
    ds_read_b64_tr_b16 v[220:221], v14 offset:4096
    ds_read_b64_tr_b16 v[222:223], v14 offset:4352
    s_add_u32 s48, s96, 2048
    s_add_u32 m0, s46, 106496
    s_nop 0
    buffer_load_dwordx4 v3, s[12:15], s48 offen lds
    v_add_u32 v224, 28672, v5
    v_add_u32 v225, 28672, v6
    v_add_u32 v226, 28672, v7
    v_add_u32 v227, 28672, v8
    s_add_u32 s47, s4, 45056
    v_add_u32 v10, s47, v9
    s_add_u32 s47, s5, 45056
    v_add_u32 v11, s47, v9
    s_add_u32 s47, s6, 45056
    v_add_u32 v13, s47, v9
    s_add_u32 s47, s7, 45056
    v_add_u32 v14, s47, v9
    s_mul_i32 s47, s41, 192
    s_mul_i32 s3, s43, 44032
    s_add_u32 s47, s47, s3
    s_mul_i32 s3, s46, 3
    v_add_u32 v26, 0, v0
    v_mul_u32_u24 v27, 43691, v26
    v_lshrrev_b32 v27, 19, v27
    v_lshlrev_b32 v26, 4, v26
    v_mul_u32_u24 v27, 2560, v27
    v_add3_u32 v4, v26, v27, s47
    v_add_u32 v26, 64, v0
    v_mul_u32_u24 v27, 43691, v26
    v_lshrrev_b32 v27, 19, v27
    v_lshlrev_b32 v26, 4, v26
    v_mul_u32_u24 v27, 2560, v27
    v_add3_u32 v19, v26, v27, s47
    v_add_u32 v26, 128, v0
    v_mul_u32_u24 v27, 43691, v26
    v_lshrrev_b32 v27, 19, v27
    v_lshlrev_b32 v26, 4, v26
    v_mul_u32_u24 v27, 2560, v27
    v_add3_u32 v20, v26, v27, s47
    v_bfe_u32 v26, v0, 2, 2
    v_lshlrev_b32 v26, 7, v26
    v_add_u32 v22, v22, v26
    v_mul_u32_u24 v26, 96, v12
    v_add_u32 v22, v22, v26
    s_waitcnt vmcnt(8)
    s_barrier
    s_waitcnt lgkmcnt(10)
    v_mfma_f32_32x32x16_bf16 v[160:175], v[192:195], v[80:83], v[160:175]
    v_mfma_f32_32x32x16_bf16 v[176:191], v[80:83], v[196:199], v[176:191]
    ds_read_b128 v[96:99], v224
    ds_read_b64_tr_b16 v[192:193], v10 offset:0
    ds_read_b64_tr_b16 v[194:195], v10 offset:256
    ds_read_b64_tr_b16 v[196:197], v10 offset:4096
    ds_read_b64_tr_b16 v[198:199], v10 offset:4352
    s_add_u32 s48, s100, 7
    s_and_b32 s48, s48, 7
    s_mul_i32 s96, s48, 196608
    s_lshl_b32 s97, s48, 7
    s_add_u32 m0, s45, 114688
    s_nop 0
    buffer_load_dwordx4 v1, s[8:11], s97 offen lds
    s_waitcnt lgkmcnt(10)
    v_mfma_f32_32x32x16_bf16 v[160:175], v[200:203], v[84:87], v[160:175]
    v_mfma_f32_32x32x16_bf16 v[176:191], v[84:87], v[204:207], v[176:191]
    ds_read_b128 v[100:103], v225
    ds_read_b64_tr_b16 v[200:201], v11 offset:0
    ds_read_b64_tr_b16 v[202:203], v11 offset:256
    ds_read_b64_tr_b16 v[204:205], v11 offset:4096
    ds_read_b64_tr_b16 v[206:207], v11 offset:4352
    s_add_u32 m0, s45, 115712
    s_nop 0
    buffer_load_dwordx4 v2, s[8:11], s97 offen lds
    s_waitcnt lgkmcnt(10)
    v_mfma_f32_32x32x16_bf16 v[160:175], v[208:211], v[88:91], v[160:175]
    v_mfma_f32_32x32x16_bf16 v[176:191], v[88:91], v[212:215], v[176:191]
    ds_read_b128 v[104:107], v226
    ds_read_b64_tr_b16 v[208:209], v13 offset:0
    ds_read_b64_tr_b16 v[210:211], v13 offset:256
    ds_read_b64_tr_b16 v[212:213], v13 offset:4096
    ds_read_b64_tr_b16 v[214:215], v13 offset:4352
    s_add_u32 s48, s96, 1024
    s_add_u32 m0, s46, 131072
    s_nop 0
    buffer_load_dwordx4 v3, s[12:15], s48 offen lds
    s_waitcnt lgkmcnt(10)
    v_mfma_f32_32x32x16_bf16 v[160:175], v[216:219], v[92:95], v[160:175]
    v_mfma_f32_32x32x16_bf16 v[176:191], v[92:95], v[220:223], v[176:191]
    v_mfma_f32_16x16x32_bf16 v[248:251], v[240:243], v[216:219], v[248:251]
    v_mfma_f32_16x16x32_bf16 v[28:31], v[240:243], v[220:223], v[28:31]
    ds_read_b128 v[108:111], v227
    ds_read_b64_tr_b16 v[216:217], v14 offset:0
    ds_read_b64_tr_b16 v[218:219], v14 offset:256
    ds_read_b64_tr_b16 v[220:221], v14 offset:4096
    ds_read_b64_tr_b16 v[222:223], v14 offset:4352
    s_add_u32 s48, s96, 2048
    s_add_u32 m0, s46, 135168
    s_nop 0
    buffer_load_dwordx4 v3, s[12:15], s48 offen lds
    v_add_u32 v224, 57344, v5
    v_add_u32 v225, 57344, v6
    v_add_u32 v226, 57344, v7
    v_add_u32 v227, 57344, v8
    s_add_u32 s47, s4, 73728
    v_add_u32 v10, s47, v9
    s_add_u32 s47, s5, 73728
    v_add_u32 v11, s47, v9
    s_add_u32 s47, s6, 73728
    v_add_u32 v13, s47, v9
    s_add_u32 s47, s7, 73728
    v_add_u32 v14, s47, v9
    buffer_load_dwordx2 v[24:25], v23, s[36:39], 0 offen sc1
    s_waitcnt vmcnt(9)
    s_barrier
    s_waitcnt lgkmcnt(10)
    v_mfma_f32_32x32x16_bf16 v[160:175], v[192:195], v[96:99], v[160:175]
    v_mfma_f32_32x32x16_bf16 v[176:191], v[96:99], v[196:199], v[176:191]
    ds_read_b128 v[112:115], v224
    ds_read_b64_tr_b16 v[192:193], v10 offset:0
    ds_read_b64_tr_b16 v[194:195], v10 offset:256
    ds_read_b64_tr_b16 v[196:197], v10 offset:4096
    ds_read_b64_tr_b16 v[198:199], v10 offset:4352
    s_add_u32 s96, s100, 0
    s_and_b32 s96, s96, 7
    s_mul_i32 s96, s96, 176128
    s_add_u32 m0, s3, 0
    s_nop 0
    buffer_load_dwordx4 v4, s[16:19], s96 offen lds
    s_waitcnt lgkmcnt(10)
    v_mfma_f32_32x32x16_bf16 v[160:175], v[200:203], v[100:103], v[160:175]
    v_mfma_f32_32x32x16_bf16 v[176:191], v[100:103], v[204:207], v[176:191]
    ds_read_b128 v[116:119], v225
    ds_read_b64_tr_b16 v[200:201], v11 offset:0
    ds_read_b64_tr_b16 v[202:203], v11 offset:256
    ds_read_b64_tr_b16 v[204:205], v11 offset:4096
    ds_read_b64_tr_b16 v[206:207], v11 offset:4352
    s_add_u32 m0, s3, 1024
    s_nop 0
    buffer_load_dwordx4 v19, s[16:19], s96 offen lds
    s_waitcnt lgkmcnt(10)
    v_mfma_f32_32x32x16_bf16 v[160:175], v[208:211], v[104:107], v[160:175]
    v_mfma_f32_32x32x16_bf16 v[176:191], v[104:107], v[212:215], v[176:191]
    ds_read_b128 v[120:123], v226
    ds_read_b64_tr_b16 v[208:209], v13 offset:0
    ds_read_b64_tr_b16 v[210:211], v13 offset:256
    ds_read_b64_tr_b16 v[212:213], v13 offset:4096
    ds_read_b64_tr_b16 v[214:215], v13 offset:4352
    s_add_u32 m0, s3, 2048
    s_nop 0
    buffer_load_dwordx4 v20, s[16:19], s96 offen lds
    s_waitcnt lgkmcnt(10)
    v_mfma_f32_32x32x16_bf16 v[160:175], v[216:219], v[108:111], v[160:175]
    v_mfma_f32_32x32x16_bf16 v[176:191], v[108:111], v[220:223], v[176:191]
    v_mfma_f32_16x16x32_bf16 v[248:251], v[240:243], v[216:219], v[248:251]
    v_mfma_f32_16x16x32_bf16 v[28:31], v[240:243], v[220:223], v[28:31]
    ds_read_b128 v[124:127], v227
    ds_read_b64_tr_b16 v[216:217], v14 offset:0
    ds_read_b64_tr_b16 v[218:219], v14 offset:256
    ds_read_b64_tr_b16 v[220:221], v14 offset:4096
    ds_read_b64_tr_b16 v[222:223], v14 offset:4352
    v_add_u32 v224, 86016, v5
    v_add_u32 v225, 86016, v6
    v_add_u32 v226, 86016, v7
    v_add_u32 v227, 86016, v8
    s_add_u32 s47, s4, 102400
    v_add_u32 v10, s47, v9
    s_add_u32 s47, s5, 102400
    v_add_u32 v11, s47, v9
    s_add_u32 s47, s6, 102400
    v_add_u32 v13, s47, v9
    s_add_u32 s47, s7, 102400
    v_add_u32 v14, s47, v9
    s_waitcnt vmcnt(8)
    s_barrier
    s_waitcnt lgkmcnt(10)
    v_mfma_f32_32x32x16_bf16 v[160:175], v[192:195], v[112:115], v[160:175]
    v_mfma_f32_32x32x16_bf16 v[176:191], v[112:115], v[196:199], v[176:191]
    ds_read_b128 v[128:131], v224
    ds_read_b64_tr_b16 v[192:193], v10 offset:0
    ds_read_b64_tr_b16 v[194:195], v10 offset:256
    ds_read_b64_tr_b16 v[196:197], v10 offset:4096
    ds_read_b64_tr_b16 v[198:199], v10 offset:4352
    s_add_u32 s96, s100, 2
    s_and_b32 s96, s96, 7
    s_mul_i32 s96, s96, 176128
    s_add_u32 m0, s3, 28672
    s_nop 0
    buffer_load_dwordx4 v4, s[16:19], s96 offen lds
    s_waitcnt lgkmcnt(10)
    v_mfma_f32_32x32x16_bf16 v[160:175], v[200:203], v[116:119], v[160:175]
    v_mfma_f32_32x32x16_bf16 v[176:191], v[116:119], v[204:207], v[176:191]
    ds_read_b128 v[132:135], v225
    ds_read_b64_tr_b16 v[200:201], v11 offset:0
    ds_read_b64_tr_b16 v[202:203], v11 offset:256
    ds_read_b64_tr_b16 v[204:205], v11 offset:4096
    ds_read_b64_tr_b16 v[206:207], v11 offset:4352
    s_add_u32 m0, s3, 29696
    s_nop 0
    buffer_load_dwordx4 v19, s[16:19], s96 offen lds
    s_waitcnt lgkmcnt(10)
    v_mfma_f32_32x32x16_bf16 v[160:175], v[208:211], v[120:123], v[160:175]
    v_mfma_f32_32x32x16_bf16 v[176:191], v[120:123], v[212:215], v[176:191]
    ds_read_b128 v[136:139], v226
    ds_read_b64_tr_b16 v[208:209], v13 offset:0
    ds_read_b64_tr_b16 v[210:211], v13 offset:256
    ds_read_b64_tr_b16 v[212:213], v13 offset:4096
    ds_read_b64_tr_b16 v[214:215], v13 offset:4352
    s_add_u32 m0, s3, 30720
    s_nop 0
    buffer_load_dwordx4 v20, s[16:19], s96 offen lds
    s_waitcnt lgkmcnt(10)
    v_mfma_f32_32x32x16_bf16 v[160:175], v[216:219], v[124:127], v[160:175]
    v_mfma_f32_32x32x16_bf16 v[176:191], v[124:127], v[220:223], v[176:191]
    v_mfma_f32_16x16x32_bf16 v[248:251], v[240:243], v[216:219], v[248:251]
    v_mfma_f32_16x16x32_bf16 v[28:31], v[240:243], v[220:223], v[28:31]
    ds_read_b128 v[140:143], v227
    ds_read_b64_tr_b16 v[216:217], v14 offset:0
    ds_read_b64_tr_b16 v[218:219], v14 offset:256
    ds_read_b64_tr_b16 v[220:221], v14 offset:4096
    ds_read_b64_tr_b16 v[222:223], v14 offset:4352
    v_add_u32 v224, 114688, v5
    v_add_u32 v225, 114688, v6
    v_add_u32 v226, 114688, v7
    v_add_u32 v227, 114688, v8
    s_add_u32 s47, s4, 131072
    v_add_u32 v10, s47, v9
    s_add_u32 s47, s5, 131072
    v_add_u32 v11, s47, v9
    s_add_u32 s47, s6, 131072
    v_add_u32 v13, s47, v9
    s_add_u32 s47, s7, 131072
    v_add_u32 v14, s47, v9
    s_waitcnt vmcnt(7)
    s_barrier
    s_waitcnt lgkmcnt(10)
    v_mfma_f32_32x32x16_bf16 v[160:175], v[192:195], v[128:131], v[160:175]
    v_mfma_f32_32x32x16_bf16 v[176:191], v[128:131], v[196:199], v[176:191]
    ds_read_b128 v[144:147], v224
    ds_read_b64_tr_b16 v[192:193], v10 offset:0
    ds_read_b64_tr_b16 v[194:195], v10 offset:256
    ds_read_b64_tr_b16 v[196:197], v10 offset:4096
    ds_read_b64_tr_b16 v[198:199], v10 offset:4352
    s_add_u32 s96, s100, 4
    s_and_b32 s96, s96, 7
    s_mul_i32 s96, s96, 176128
    s_add_u32 m0, s3, 57344
    s_nop 0
    buffer_load_dwordx4 v4, s[16:19], s96 offen lds
    s_waitcnt lgkmcnt(10)
    v_mfma_f32_32x32x16_bf16 v[160:175], v[200:203], v[132:135], v[160:175]
    v_mfma_f32_32x32x16_bf16 v[176:191], v[132:135], v[204:207], v[176:191]
    ds_read_b128 v[148:151], v225
    ds_read_b64_tr_b16 v[200:201], v11 offset:0
    ds_read_b64_tr_b16 v[202:203], v11 offset:256
    ds_read_b64_tr_b16 v[204:205], v11 offset:4096
    ds_read_b64_tr_b16 v[206:207], v11 offset:4352
    s_add_u32 m0, s3, 58368
    s_nop 0
    buffer_load_dwordx4 v19, s[16:19], s96 offen lds
    s_waitcnt lgkmcnt(10)
    v_mfma_f32_32x32x16_bf16 v[160:175], v[208:211], v[136:139], v[160:175]
    v_mfma_f32_32x32x16_bf16 v[176:191], v[136:139], v[212:215], v[176:191]
    ds_read_b128 v[152:155], v226
    ds_read_b64_tr_b16 v[208:209], v13 offset:0
    ds_read_b64_tr_b16 v[210:211], v13 offset:256
    ds_read_b64_tr_b16 v[212:213], v13 offset:4096
    ds_read_b64_tr_b16 v[214:215], v13 offset:4352
    s_add_u32 m0, s3, 59392
    s_nop 0
    buffer_load_dwordx4 v20, s[16:19], s96 offen lds
    s_waitcnt lgkmcnt(10)
    v_mfma_f32_32x32x16_bf16 v[160:175], v[216:219], v[140:143], v[160:175]
    v_mfma_f32_32x32x16_bf16 v[176:191], v[140:143], v[220:223], v[176:191]
    v_mfma_f32_16x16x32_bf16 v[248:251], v[240:243], v[216:219], v[248:251]
    v_mfma_f32_16x16x32_bf16 v[28:31], v[240:243], v[220:223], v[28:31]
    ds_read_b128 v[156:159], v227
    ds_read_b64_tr_b16 v[216:217], v14 offset:0
    ds_read_b64_tr_b16 v[218:219], v14 offset:256
    ds_read_b64_tr_b16 v[220:221], v14 offset:4096
    ds_read_b64_tr_b16 v[222:223], v14 offset:4352
    s_waitcnt lgkmcnt(10)
    v_mfma_f32_32x32x16_bf16 v[160:175], v[192:195], v[144:147], v[160:175]
    v_mfma_f32_32x32x16_bf16 v[176:191], v[144:147], v[196:199], v[176:191]
    s_waitcnt lgkmcnt(10)
    v_mfma_f32_32x32x16_bf16 v[160:175], v[200:203], v[148:151], v[160:175]
    v_mfma_f32_32x32x16_bf16 v[176:191], v[148:151], v[204:207], v[176:191]
    s_waitcnt lgkmcnt(5)
    v_mfma_f32_32x32x16_bf16 v[160:175], v[208:211], v[152:155], v[160:175]
    v_mfma_f32_32x32x16_bf16 v[176:191], v[152:155], v[212:215], v[176:191]
    s_waitcnt lgkmcnt(0)
    v_mfma_f32_32x32x16_bf16 v[160:175], v[216:219], v[156:159], v[160:175]
    v_mfma_f32_32x32x16_bf16 v[176:191], v[156:159], v[220:223], v[176:191]
    v_mfma_f32_16x16x32_bf16 v[248:251], v[240:243], v[216:219], v[248:251]
    v_mfma_f32_16x16x32_bf16 v[28:31], v[240:243], v[220:223], v[28:31]
    v_and_b32 v10, 31, v0
    v_lshlrev_b32 v10, 4, v10
    s_lshl_b32 s47, s43, 2
    v_add_u32 v11, s47, v10
    s_nop 6
    v_cvt_pk_bf16_f32 v249, v248, v248
    v_lshlrev_b32 v249, 16, v249
    v_sub_f32 v249, v248, v249
    v_cvt_pk_bf16_f32 v250, v248, v249
    ds_write_b32 v11, v250 offset:24576
    v_cvt_pk_bf16_f32 v29, v28, v28
    v_lshlrev_b32 v29, 16, v29
    v_sub_f32 v29, v28, v29
    v_cvt_pk_bf16_f32 v30, v28, v29
    ds_write_b32 v11, v30 offset:25088
    v_lshrrev_b32 v13, 2, v10
    s_lshl_b32 s47, s43, 7
    v_add_u32 v13, s47, v13
    v_lshl_add_u32 v14, v12, 5, v13
    s_waitcnt vmcnt(9)
    s_mov_b32 s47, 0x40000
np_1:
    v_readfirstlane_b32 s56, v24
    v_readfirstlane_b32 s57, v25
    s_cmp_lg_u32 s56, 0
    s_cbranch_scc1 nd_2
    s_sub_u32 s47, s47, 1
    s_cbranch_scc1 nd_2
    s_sleep 1
    buffer_load_dwordx2 v[24:25], v23, s[36:39], 0 offen sc1
    s_waitcnt vmcnt(0)
    s_branch np_1
nd_2:
    s_waitcnt lgkmcnt(0)
    s_setprio 0
    s_barrier
    s_add_u32 s96, s100, 6
    s_and_b32 s96, s96, 7
    s_mul_i32 s96, s96, 176128
    s_add_u32 m0, s3, 86016
    s_nop 0
    buffer_load_dwordx4 v4, s[16:19], s96 offen lds
    s_add_u32 m0, s3, 87040
    s_nop 0
    buffer_load_dwordx4 v19, s[16:19], s96 offen lds
    s_add_u32 m0, s3, 88064
    s_nop 0
    buffer_load_dwordx4 v20, s[16:19], s96 offen lds
    ds_read_b32 v27, v14 offset:53760
    ds_read_b128 v[192:195], v10 offset:24576
    ds_read_b128 v[196:199], v10 offset:25088
    ds_read_b32 v26, v13 offset:53248
    s_lshl_b32 s47, s43, 7
    v_add_u32 v11, s47, v12
    ds_read_b128 v[208:211], v11 offset:53248
    ds_read_b128 v[212:215], v11 offset:53280
    ds_read_b128 v[216:219], v11 offset:53312
    ds_read_b128 v[220:223], v11 offset:53344
    s_lshl_b32 s47, s46, 1
    s_add_u32 s47, s47, 131072
    v_add_u32 v13, s47, v21
    v_and_b32 v14, 15, v0
    v_lshlrev_b32 v14, 4, v14
    v_lshl_add_u32 v14, v12, 4, v14
    v_bfe_u32 v15, v0, 4, 1
    v_mul_u32_u24 v16, 24576, v15
    v_add3_u32 v16, v16, v14, s47
    v_lshl_add_u32 v14, v15, 17, v14
    s_lshl_b32 s47, s41, 7
    s_add_u32 s47, s47, s59
    s_lshl_b32 s47, s47, 11
    s_add_u32 s47, s47, 1048576
    s_add_u32 s48, s47, 131072
    s_waitcnt lgkmcnt(5)
    v_mov_b32 v244, v27
    v_mov_b32 v245, v27
    v_mov_b32 v246, v27
    v_mov_b32 v247, v27
    s_nop 1
    v_mfma_f32_32x32x16_bf16 v[160:175], v[192:195], v[244:247], v[160:175]
    v_mfma_f32_32x32x16_bf16 v[176:191], v[244:247], v[196:199], v[176:191]
    s_waitcnt lgkmcnt(0)
    v_mul_f32 v19, 0xbfb8aa3b, v26
    v_rcp_f32 v20, v26
    s_nop 7
    v_mul_f32 v160, v26, v160
    v_mul_f32 v161, v26, v161
    v_mul_f32 v162, v26, v162
    v_mul_f32 v163, v26, v163
    v_mul_f32 v164, v26, v164
    v_mul_f32 v165, v26, v165
    v_mul_f32 v166, v26, v166
    v_mul_f32 v167, v26, v167
    v_mul_f32 v168, v26, v168
    v_mul_f32 v169, v26, v169
    v_mul_f32 v170, v26, v170
    v_mul_f32 v171, v26, v171
    v_mul_f32 v172, v26, v172
    v_mul_f32 v173, v26, v173
    v_mul_f32 v174, v26, v174
    v_mul_f32 v175, v26, v175
    v_cvt_pk_bf16_f32 v192, v160, v161
    v_cvt_pk_bf16_f32 v193, v162, v163
    v_cvt_pk_bf16_f32 v194, v164, v165
    v_cvt_pk_bf16_f32 v195, v166, v167
    v_cvt_pk_bf16_f32 v196, v168, v169
    v_cvt_pk_bf16_f32 v197, v170, v171
    v_cvt_pk_bf16_f32 v198, v172, v173
    v_cvt_pk_bf16_f32 v199, v174, v175
    buffer_store_dwordx4 v[192:195], v21, s[32:35], s47 offen sc1
    buffer_store_dwordx4 v[196:199], v21, s[32:35], s48 offen sc1
    ds_write_b128 v13, v[192:195]
    ds_write_b128 v13, v[196:199] offset:24576
    v_mul_f32 v176, v208, v176
    v_mul_f32 v177, v209, v177
    v_mul_f32 v178, v210, v178
    v_mul_f32 v179, v211, v179
    v_mul_f32 v180, v212, v180
    v_mul_f32 v181, v213, v181
    v_mul_f32 v182, v214, v182
    v_mul_f32 v183, v215, v183
    v_mul_f32 v184, v216, v184
    v_mul_f32 v185, v217, v185
    v_mul_f32 v186, v218, v186
    v_mul_f32 v187, v219, v187
    v_mul_f32 v188, v220, v188
    v_mul_f32 v189, v221, v189
    v_mul_f32 v190, v222, v190
    v_mul_f32 v191, v223, v191
    v_cvt_pk_bf16_f32 v200, v176, v177
    v_cvt_pk_bf16_f32 v201, v178, v179
    v_cvt_pk_bf16_f32 v202, v180, v181
    v_cvt_pk_bf16_f32 v203, v182, v183
    v_cvt_pk_bf16_f32 v204, v184, v185
    v_cvt_pk_bf16_f32 v205, v186, v187
    v_cvt_pk_bf16_f32 v206, v188, v189
    v_cvt_pk_bf16_f32 v207, v190, v191
    buffer_store_dwordx4 v[200:203], v14, s[32:35], s47 offen offset:1024 sc1
    buffer_store_dwordx4 v[204:207], v14, s[32:35], s47 offen offset:1536 sc1
    ds_write_b128 v16, v[200:203] offset:1024
    ds_write_b128 v16, v[204:207] offset:1536
    s_waitcnt lgkmcnt(0)
    s_mul_i32 s47, s4, 3
    s_add_u32 s47, s47, 0
    v_add_u32 v15, s47, v22
    s_mul_i32 s47, s5, 3
    s_add_u32 s47, s47, 0
    v_add_u32 v16, s47, v22
    s_mul_i32 s47, s6, 3
    s_add_u32 s47, s47, 0
    v_add_u32 v17, s47, v22
    s_mul_i32 s47, s7, 3
    s_add_u32 s47, s47, 0
    v_add_u32 v18, s47, v22
    ds_read_b64_tr_b16 v[208:209], v15 offset:0
    ds_read_b64_tr_b16 v[210:211], v15 offset:768
    ds_read_b64_tr_b16 v[212:213], v16 offset:0
    ds_read_b64_tr_b16 v[214:215], v16 offset:768
    ds_read_b64_tr_b16 v[216:217], v17 offset:0
    ds_read_b64_tr_b16 v[218:219], v17 offset:768
    ds_read_b64_tr_b16 v[220:221], v18 offset:0
    ds_read_b64_tr_b16 v[222:223], v18 offset:768
    s_waitcnt lgkmcnt(6)
    v_mfma_f32_32x32x16_bf16 v[160:175], v[208:211], v[32:35], 0
    ds_read_b64_tr_b16 v[224:225], v15 offset:12288
    ds_read_b64_tr_b16 v[226:227], v15 offset:13056
    v_mfma_f32_16x16x32_bf16 v[248:251], v[240:243], v[208:211], 0
    s_waitcnt lgkmcnt(6)
    v_mfma_f32_32x32x16_bf16 v[160:175], v[212:215], v[36:39], v[160:175]
    ds_read_b64_tr_b16 v[208:209], v16 offset:12288
    ds_read_b64_tr_b16 v[210:211], v16 offset:13056
    s_waitcnt lgkmcnt(6)
    v_mfma_f32_32x32x16_bf16 v[160:175], v[216:219], v[40:43], v[160:175]
    ds_read_b64_tr_b16 v[212:213], v17 offset:12288
    ds_read_b64_tr_b16 v[214:215], v17 offset:13056
    s_waitcnt lgkmcnt(6)
    v_mfma_f32_32x32x16_bf16 v[160:175], v[220:223], v[44:47], v[160:175]
    ds_read_b64_tr_b16 v[216:217], v18 offset:12288
    ds_read_b64_tr_b16 v[218:219], v18 offset:13056
    s_waitcnt lgkmcnt(6)
    v_mfma_f32_32x32x16_bf16 v[160:175], v[224:227], v[48:51], v[160:175]
    s_waitcnt vmcnt(10)
    s_barrier
    s_mul_i32 s47, s4, 3
    s_add_u32 s47, s47, 28672
    v_add_u32 v15, s47, v22
    s_mul_i32 s47, s5, 3
    s_add_u32 s47, s47, 28672
    v_add_u32 v16, s47, v22
    s_mul_i32 s47, s6, 3
    s_add_u32 s47, s47, 28672
    v_add_u32 v17, s47, v22
    s_mul_i32 s47, s7, 3
    s_add_u32 s47, s47, 28672
    v_add_u32 v18, s47, v22
    ds_read_b64_tr_b16 v[220:221], v15 offset:0
    ds_read_b64_tr_b16 v[222:223], v15 offset:768
    v_mfma_f32_16x16x32_bf16 v[248:251], v[240:243], v[224:227], v[248:251]
    s_waitcnt lgkmcnt(6)
    v_mfma_f32_32x32x16_bf16 v[160:175], v[208:211], v[52:55], v[160:175]
    ds_read_b64_tr_b16 v[224:225], v16 offset:0
    ds_read_b64_tr_b16 v[226:227], v16 offset:768
    s_waitcnt lgkmcnt(6)
    v_mfma_f32_32x32x16_bf16 v[160:175], v[212:215], v[56:59], v[160:175]
    ds_read_b64_tr_b16 v[208:209], v17 offset:0
    ds_read_b64_tr_b16 v[210:211], v17 offset:768
    s_waitcnt lgkmcnt(6)
    v_mfma_f32_32x32x16_bf16 v[160:175], v[216:219], v[60:63], v[160:175]
    ds_read_b64_tr_b16 v[212:213], v18 offset:0
    ds_read_b64_tr_b16 v[214:215], v18 offset:768
    s_waitcnt lgkmcnt(6)
    v_mfma_f32_32x32x16_bf16 v[160:175], v[220:223], v[64:67], v[160:175]
    ds_read_b64_tr_b16 v[216:217], v15 offset:12288
    ds_read_b64_tr_b16 v[218:219], v15 offset:13056
    v_mfma_f32_16x16x32_bf16 v[248:251], v[240:243], v[220:223], v[248:251]
    s_waitcnt lgkmcnt(6)
    v_mfma_f32_32x32x16_bf16 v[160:175], v[224:227], v[68:71], v[160:175]
    ds_read_b64_tr_b16 v[220:221], v16 offset:12288
    ds_read_b64_tr_b16 v[222:223], v16 offset:13056
    s_waitcnt lgkmcnt(6)
    v_mfma_f32_32x32x16_bf16 v[160:175], v[208:211], v[72:75], v[160:175]
    ds_read_b64_tr_b16 v[224:225], v17 offset:12288
    ds_read_b64_tr_b16 v[226:227], v17 offset:13056
    s_waitcnt lgkmcnt(6)
    v_mfma_f32_32x32x16_bf16 v[160:175], v[212:215], v[76:79], v[160:175]
    ds_read_b64_tr_b16 v[208:209], v18 offset:12288
    ds_read_b64_tr_b16 v[210:211], v18 offset:13056
    s_waitcnt vmcnt(0)
    s_mov_b64 exec, 1
    s_add_u32 s47, s62, 0
    buffer_store_dwordx2 v[24:25], v0, s[32:35], s47 offen sc1
    s_mov_b64 exec, -1
    s_waitcnt lgkmcnt(4)
    v_mfma_f32_32x32x16_bf16 v[160:175], v[216:219], v[80:83], v[160:175]
    s_barrier
    s_mul_i32 s47, s4, 3
    s_add_u32 s47, s47, 57344
    v_add_u32 v15, s47, v22
    s_mul_i32 s47, s5, 3
    s_add_u32 s47, s47, 57344
    v_add_u32 v16, s47, v22
    s_mul_i32 s47, s6, 3
    s_add_u32 s47, s47, 57344
    v_add_u32 v17, s47, v22
    s_mul_i32 s47, s7, 3
    s_add_u32 s47, s47, 57344
    v_add_u32 v18, s47, v22
    ds_read_b64_tr_b16 v[212:213], v15 offset:0
    ds_read_b64_tr_b16 v[214:215], v15 offset:768
    ds_read_b64_tr_b16 v[176:177], v15 offset:0
    ds_read_b64_tr_b16 v[178:179], v15 offset:768
    ds_read_b64_tr_b16 v[180:181], v15 offset:12288
    ds_read_b64_tr_b16 v[182:183], v15 offset:13056
    ds_read_b64_tr_b16 v[184:185], v15 offset:28672
    ds_read_b64_tr_b16 v[186:187], v15 offset:29440
    ds_read_b64_tr_b16 v[188:189], v15 offset:40960
    ds_read_b64_tr_b16 v[190:191], v15 offset:41728
    v_mfma_f32_16x16x32_bf16 v[248:251], v[240:243], v[216:219], v[248:251]
    s_waitcnt lgkmcnt(6)
    v_mfma_f32_32x32x16_bf16 v[160:175], v[220:223], v[84:87], v[160:175]
    ds_read_b64_tr_b16 v[216:217], v16 offset:0
    ds_read_b64_tr_b16 v[218:219], v16 offset:768
    s_waitcnt lgkmcnt(0)
    v_mfma_f32_16x16x32_bf16 v[248:251], v[240:243], v[176:179], v[248:251]
    v_mfma_f32_16x16x32_bf16 v[248:251], v[240:243], v[180:183], v[248:251]
    v_mfma_f32_16x16x32_bf16 v[248:251], v[240:243], v[184:187], v[248:251]
    v_mfma_f32_16x16x32_bf16 v[248:251], v[240:243], v[188:191], v[248:251]
    s_waitcnt lgkmcnt(6)
    v_mfma_f32_32x32x16_bf16 v[160:175], v[224:227], v[88:91], v[160:175]
    ds_read_b64_tr_b16 v[220:221], v17 offset:0
    ds_read_b64_tr_b16 v[222:223], v17 offset:768
    s_waitcnt lgkmcnt(6)
    v_mfma_f32_32x32x16_bf16 v[160:175], v[208:211], v[92:95], v[160:175]
    ds_read_b64_tr_b16 v[224:225], v18 offset:0
    ds_read_b64_tr_b16 v[226:227], v18 offset:768
    v_and_b32 v10, 31, v0
    v_lshlrev_b32 v10, 4, v10
    s_lshl_b32 s47, s43, 2
    v_add_u32 v11, s47, v10
    v_cvt_pk_bf16_f32 v249, v248, v248
    v_lshlrev_b32 v249, 16, v249
    v_sub_f32 v249, v248, v249
    v_cvt_pk_bf16_f32 v250, v248, v249
    ds_write_b32 v11, v250 offset:26112
    s_waitcnt lgkmcnt(0)
    s_waitcnt lgkmcnt(6)
    v_mfma_f32_32x32x16_bf16 v[160:175], v[212:215], v[96:99], v[160:175]
    ds_read_b64_tr_b16 v[208:209], v15 offset:12288
    ds_read_b64_tr_b16 v[210:211], v15 offset:13056
    s_waitcnt lgkmcnt(6)
    v_mfma_f32_32x32x16_bf16 v[160:175], v[216:219], v[100:103], v[160:175]
    ds_read_b64_tr_b16 v[212:213], v16 offset:12288
    ds_read_b64_tr_b16 v[214:215], v16 offset:13056
    s_waitcnt lgkmcnt(6)
    v_mfma_f32_32x32x16_bf16 v[160:175], v[220:223], v[104:107], v[160:175]
    ds_read_b64_tr_b16 v[216:217], v17 offset:12288
    ds_read_b64_tr_b16 v[218:219], v17 offset:13056
    s_waitcnt lgkmcnt(6)
    v_mfma_f32_32x32x16_bf16 v[160:175], v[224:227], v[108:111], v[160:175]
    ds_read_b64_tr_b16 v[220:221], v18 offset:12288
    ds_read_b64_tr_b16 v[222:223], v18 offset:13056
    s_waitcnt lgkmcnt(6)
    v_mfma_f32_32x32x16_bf16 v[160:175], v[208:211], v[112:115], v[160:175]
    s_mul_i32 s47, s4, 3
    s_add_u32 s47, s47, 86016
    v_add_u32 v15, s47, v22
    s_mul_i32 s47, s5, 3
    s_add_u32 s47, s47, 86016
    v_add_u32 v16, s47, v22
    s_mul_i32 s47, s6, 3
    s_add_u32 s47, s47, 86016
    v_add_u32 v17, s47, v22
    s_mul_i32 s47, s7, 3
    s_add_u32 s47, s47, 86016
    v_add_u32 v18, s47, v22
    ds_read_b64_tr_b16 v[224:225], v15 offset:0
    ds_read_b64_tr_b16 v[226:227], v15 offset:768
    s_and_b32 s49, s42, 1
    s_lshr_b32 s55, s42, 1
    s_mul_i32 s50, s55, 28672
    s_lshl_b32 s47, s49, 10
    s_add_u32 s50, s50, s47
    s_mul_i32 s51, s55, 12288
    s_add_u32 s51, s51, s47
    s_add_u32 s51, s51, 114688
    s_mul_i32 s52, s55, 360448
    s_lshl_b32 s53, s55, 17
    v_lshrrev_b32 v3, 5, v0
    v_bfe_u32 v11, v0, 2, 2
    v_lshl_add_u32 v3, v3, 2, v11
    v_lshlrev_b32 v3, 10, v3
    v_bfe_u32 v11, v0, 4, 1
    v_lshl_add_u32 v3, v11, 6, v3
    v_and_b32 v11, 3, v0
    v_lshl_add_u32 v3, v11, 4, v3
    s_lshr_b32 s47, s41, 1
    s_lshl_b32 s47, s47, 7
    s_lshl_b32 s48, s49, 13
    s_add_u32 s47, s47, s48
    v_add_u32 v3, s47, v3
    s_waitcnt lgkmcnt(6)
    v_mfma_f32_32x32x16_bf16 v[160:175], v[212:215], v[116:119], v[160:175]
    ds_read_b64_tr_b16 v[208:209], v16 offset:0
    ds_read_b64_tr_b16 v[210:211], v16 offset:768
    s_waitcnt lgkmcnt(6)
    v_mfma_f32_32x32x16_bf16 v[160:175], v[216:219], v[120:123], v[160:175]
    ds_read_b64_tr_b16 v[212:213], v17 offset:0
    ds_read_b64_tr_b16 v[214:215], v17 offset:768
    s_waitcnt lgkmcnt(6)
    v_mfma_f32_32x32x16_bf16 v[160:175], v[220:223], v[124:127], v[160:175]
    ds_read_b64_tr_b16 v[216:217], v18 offset:0
    ds_read_b64_tr_b16 v[218:219], v18 offset:768
    s_waitcnt lgkmcnt(6)
    v_mfma_f32_32x32x16_bf16 v[160:175], v[224:227], v[128:131], v[160:175]
    ds_read_b64_tr_b16 v[220:221], v15 offset:12288
    ds_read_b64_tr_b16 v[222:223], v15 offset:13056
    s_barrier
    s_add_u32 s48, s52, 0
    s_add_u32 m0, s50, 0
    s_nop 0
    buffer_load_dwordx4 v3, s[20:23], s48 offen lds
    s_waitcnt lgkmcnt(6)
    v_mfma_f32_32x32x16_bf16 v[160:175], v[208:211], v[132:135], v[160:175]
    ds_read_b64_tr_b16 v[224:225], v16 offset:12288
    ds_read_b64_tr_b16 v[226:227], v16 offset:13056
    s_add_u32 s48, s52, 16384
    s_add_u32 m0, s50, 2048
    s_nop 0
    buffer_load_dwordx4 v3, s[20:23], s48 offen lds
    s_waitcnt lgkmcnt(6)
    v_mfma_f32_32x32x16_bf16 v[160:175], v[212:215], v[136:139], v[160:175]
    ds_read_b64_tr_b16 v[208:209], v17 offset:12288
    ds_read_b64_tr_b16 v[210:211], v17 offset:13056
    s_add_u32 s48, s52, 32768
    s_add_u32 m0, s50, 4096
    s_nop 0
    buffer_load_dwordx4 v3, s[20:23], s48 offen lds
    s_waitcnt lgkmcnt(6)
    v_mfma_f32_32x32x16_bf16 v[160:175], v[216:219], v[140:143], v[160:175]
    ds_read_b64_tr_b16 v[212:213], v18 offset:12288
    ds_read_b64_tr_b16 v[214:215], v18 offset:13056
    s_add_u32 s48, s52, 49152
    s_add_u32 m0, s50, 6144
    s_nop 0
    buffer_load_dwordx4 v3, s[20:23], s48 offen lds
    s_waitcnt lgkmcnt(6)
    v_mfma_f32_32x32x16_bf16 v[160:175], v[220:223], v[144:147], v[160:175]
    s_add_u32 s48, s52, 65536
    s_add_u32 m0, s50, 8192
    s_nop 0
    buffer_load_dwordx4 v3, s[20:23], s48 offen lds
    s_waitcnt lgkmcnt(4)
    v_mfma_f32_32x32x16_bf16 v[160:175], v[224:227], v[148:151], v[160:175]
    s_add_u32 s48, s52, 81920
    s_add_u32 m0, s50, 10240
    s_nop 0
    buffer_load_dwordx4 v3, s[20:23], s48 offen lds
    s_lshl_b32 s47, s40, 2
    s_sub_u32 s47, s47, 8
    v_add_u32 v14, s47, v0
    v_max_i32 v14, 0, v14
    v_min_i32 v14, 63, v14
    v_lshlrev_b32 v14, 8, v14
    s_lshl_b32 s47, s41, 4
    v_add_u32 v14, s47, v14
    s_mov_b32 s54, 0xff
    s_cmp_eq_u32 s40, 1
    s_cselect_b32 s54, 0xf0, s54
    s_cmp_eq_u32 s40, 0
    s_cselect_b32 s54, 0, s54
    buffer_load_dwordx2 v[228:229], v14, s[32:35], 0 offen sc1
    s_waitcnt lgkmcnt(2)
    v_mfma_f32_32x32x16_bf16 v[160:175], v[208:211], v[152:155], v[160:175]
    s_add_u32 s48, s52, 98304
    s_add_u32 m0, s50, 12288
    s_nop 0
    buffer_load_dwordx4 v3, s[20:23], s48 offen lds
    s_waitcnt lgkmcnt(0)
    v_mfma_f32_32x32x16_bf16 v[160:175], v[212:215], v[156:159], v[160:175]
    s_add_u32 s48, s52, 114688
    s_add_u32 m0, s50, 14336
    s_nop 0
    buffer_load_dwordx4 v3, s[20:23], s48 offen lds
    s_add_u32 s47, s46, 81920
    v_add_u32 v11, s47, v21
    ds_read_b128 v[28:31], v11
    ds_read_b128 v[248:251], v10 offset:26112
    s_waitcnt lgkmcnt(0)
    v_mfma_f32_32x32x16_bf16 v[160:175], v[248:251], v[244:247], v[160:175]
    s_add_u32 s48, s52, 131072
    s_add_u32 m0, s50, 16384
    s_nop 0
    buffer_load_dwordx4 v3, s[20:23], s48 offen lds
    s_nop 7
    v_mul_f32 v192, v19, v160
    v_mul_f32 v193, v19, v161
    v_mul_f32 v194, v19, v162
    v_mul_f32 v195, v19, v163
    v_mul_f32 v196, v19, v164
    v_mul_f32 v197, v19, v165
    v_mul_f32 v198, v19, v166
    v_mul_f32 v199, v19, v167
    v_mul_f32 v200, v19, v168
    v_mul_f32 v201, v19, v169
    v_mul_f32 v202, v19, v170
    v_mul_f32 v203, v19, v171
    v_mul_f32 v204, v19, v172
    v_mul_f32 v205, v19, v173
    v_mul_f32 v206, v19, v174
    v_mul_f32 v207, v19, v175
    s_add_u32 s48, s52, 147456
    s_add_u32 m0, s50, 18432
    s_nop 0
    buffer_load_dwordx4 v3, s[20:23], s48 offen lds
    v_exp_f32 v192, v192
    v_exp_f32 v193, v193
    v_exp_f32 v194, v194
    v_exp_f32 v195, v195
    v_exp_f32 v196, v196
    v_exp_f32 v197, v197
    v_exp_f32 v198, v198
    v_exp_f32 v199, v199
    v_exp_f32 v200, v200
    v_exp_f32 v201, v201
    v_exp_f32 v202, v202
    v_exp_f32 v203, v203
    v_exp_f32 v204, v204
    v_exp_f32 v205, v205
    v_exp_f32 v206, v206
    v_exp_f32 v207, v207
    s_add_u32 s48, s52, 163840
    s_add_u32 m0, s50, 20480
    s_nop 0
    buffer_load_dwordx4 v3, s[20:23], s48 offen lds
    v_fma_f32 v192, v192, v20, v20
    v_fma_f32 v193, v193, v20, v20
    v_fma_f32 v194, v194, v20, v20
    v_fma_f32 v195, v195, v20, v20
    v_fma_f32 v196, v196, v20, v20
    v_fma_f32 v197, v197, v20, v20
    v_fma_f32 v198, v198, v20, v20
    v_fma_f32 v199, v199, v20, v20
    v_fma_f32 v200, v200, v20, v20
    v_fma_f32 v201, v201, v20, v20
    v_fma_f32 v202, v202, v20, v20
    v_fma_f32 v203, v203, v20, v20
    v_fma_f32 v204, v204, v20, v20
    v_fma_f32 v205, v205, v20, v20
    v_fma_f32 v206, v206, v20, v20
    v_fma_f32 v207, v207, v20, v20
    v_rcp_f32 v192, v192
    v_rcp_f32 v193, v193
    v_rcp_f32 v194, v194
    v_rcp_f32 v195, v195
    v_rcp_f32 v196, v196
    v_rcp_f32 v197, v197
    v_rcp_f32 v198, v198
    v_rcp_f32 v199, v199
    v_rcp_f32 v200, v200
    v_rcp_f32 v201, v201
    v_rcp_f32 v202, v202
    v_rcp_f32 v203, v203
    v_rcp_f32 v204, v204
    v_rcp_f32 v205, v205
    v_rcp_f32 v206, v206
    v_rcp_f32 v207, v207
    s_add_u32 s48, s52, 180224
    s_add_u32 m0, s50, 22528
    s_nop 0
    buffer_load_dwordx4 v3, s[20:23], s48 offen lds
    v_mul_f32 v160, v160, v192
    v_mul_f32 v161, v161, v193
    v_mul_f32 v162, v162, v194
    v_mul_f32 v163, v163, v195
    v_mul_f32 v164, v164, v196
    v_mul_f32 v165, v165, v197
    v_mul_f32 v166, v166, v198
    v_mul_f32 v167, v167, v199
    v_mul_f32 v168, v168, v200
    v_mul_f32 v169, v169, v201
    v_mul_f32 v170, v170, v202
    v_mul_f32 v171, v171, v203
    v_mul_f32 v172, v172, v204
    v_mul_f32 v173, v173, v205
    v_mul_f32 v174, v174, v206
    v_mul_f32 v175, v175, v207
    v_cvt_pk_bf16_f32 v192, v160, v161
    v_cvt_pk_bf16_f32 v193, v162, v163
    v_cvt_pk_bf16_f32 v194, v164, v165
    v_cvt_pk_bf16_f32 v195, v166, v167
    v_cvt_pk_bf16_f32 v196, v168, v169
    v_cvt_pk_bf16_f32 v197, v170, v171
    v_cvt_pk_bf16_f32 v198, v172, v173
    v_cvt_pk_bf16_f32 v199, v174, v175
    s_mul_i32 s47, s41, 3
    s_add_u32 s47, s47, 0
    s_cmp_lt_u32 s47, 43
    s_cbranch_scc1 nz_3
    v_mov_b32 v192, 0
    v_mov_b32 v193, 0
    v_mov_b32 v194, 0
    v_mov_b32 v195, 0
    v_mov_b32 v196, 0
    v_mov_b32 v197, 0
    v_mov_b32 v198, 0
    v_mov_b32 v199, 0
nz_3:
    s_mul_i32 s48, s59, 48
    s_add_u32 s47, s47, s48
    s_lshl_b32 s47, s47, 11
    s_add_u32 s47, s47, 7340032
    buffer_store_dwordx4 v[192:195], v21, s[32:35], s47 offen sc1
    buffer_store_dwordx4 v[196:199], v21, s[32:35], s47 offen offset:1024 sc1
    s_waitcnt vmcnt(8)
    v_cmp_ne_u64 vcc, s[56:57], v[228:229]
    s_nop 1
    s_and_b32 s101, vcc_lo, s54
    s_cbranch_scc1 Lkvlate
    s_and_b32 s47, s43, 1
    s_add_u32 s48, s40, s47
    s_cmp_lt_u32 s48, 2
    s_cbranch_scc1 nokv_4
    s_sub_u32 s48, s48, 2
    s_lshl_b32 s48, s48, 13
    s_lshr_b32 s63, s43, 1
    s_lshl_b32 s96, s41, 1
    s_add_u32 s96, s96, s63
    s_lshl_b32 s96, s96, 17
    s_add_u32 s48, s48, s96
    s_add_u32 s48, s48, 1048576
    s_mul_i32 s63, s63, 24576
    s_lshl_b32 s47, s47, 13
    s_add_u32 s47, s47, s63
    s_add_u32 m0, s47, 114688
    s_nop 0
    buffer_load_dwordx4 v21, s[32:35], s48 offen offset:0 sc1 lds
    buffer_load_dwordx4 v21, s[32:35], s48 offen offset:1024 sc1 lds
    buffer_load_dwordx4 v21, s[32:35], s48 offen offset:2048 sc1 lds
    buffer_load_dwordx4 v21, s[32:35], s48 offen offset:3072 sc1 lds
    s_add_u32 m0, s47, 118784
    s_add_u32 s48, s48, 4096
    buffer_load_dwordx4 v21, s[32:35], s48 offen offset:0 sc1 lds
    buffer_load_dwordx4 v21, s[32:35], s48 offen offset:1024 sc1 lds
    buffer_load_dwordx4 v21, s[32:35], s48 offen offset:2048 sc1 lds
    buffer_load_dwordx4 v21, s[32:35], s48 offen offset:3072 sc1 lds
nokv_4:
    s_branch Lkvj
Lkvlate:
    buffer_load_dwordx2 v[228:229], v14, s[32:35], 0 offen sc1
Lkvj:
    s_waitcnt lgkmcnt(0)
    s_barrier
    s_cmp_eq_u32 s101, 0
    s_cbranch_scc1 Lkvdone
    s_waitcnt vmcnt(0)
    s_mov_b32 s47, 0x40000
poll_5:
    v_cmp_ne_u64 vcc, s[56:57], v[228:229]
    s_nop 1
    s_and_b32 vcc_lo, vcc_lo, s54
    s_cbranch_scc0 pdone_6
    s_sub_u32 s47, s47, 1
    s_cbranch_scc1 pdone_6
    s_sleep 1
    buffer_load_dwordx2 v[228:229], v14, s[32:35], 0 offen sc1
    s_waitcnt vmcnt(0)
    s_branch poll_5
pdone_6:
    s_and_b32 s47, s43, 1
    s_add_u32 s48, s40, s47
    s_cmp_lt_u32 s48, 2
    s_cbranch_scc1 nokv_7
    s_sub_u32 s48, s48, 2
    s_lshl_b32 s48, s48, 13
    s_lshr_b32 s63, s43, 1
    s_lshl_b32 s96, s41, 1
    s_add_u32 s96, s96, s63
    s_lshl_b32 s96, s96, 17
    s_add_u32 s48, s48, s96
    s_add_u32 s48, s48, 1048576
    s_mul_i32 s63, s63, 24576
    s_lshl_b32 s47, s47, 13
    s_add_u32 s47, s47, s63
    s_add_u32 m0, s47, 114688
    s_nop 0
    buffer_load_dwordx4 v21, s[32:35], s48 offen offset:0 sc1 lds
    buffer_load_dwordx4 v21, s[32:35], s48 offen offset:1024 sc1 lds
    buffer_load_dwordx4 v21, s[32:35], s48 offen offset:2048 sc1 lds
    buffer_load_dwordx4 v21, s[32:35], s48 offen offset:3072 sc1 lds
    s_add_u32 m0, s47, 118784
    s_add_u32 s48, s48, 4096
    buffer_load_dwordx4 v21, s[32:35], s48 offen offset:0 sc1 lds
    buffer_load_dwordx4 v21, s[32:35], s48 offen offset:1024 sc1 lds
    buffer_load_dwordx4 v21, s[32:35], s48 offen offset:2048 sc1 lds
    buffer_load_dwordx4 v21, s[32:35], s48 offen offset:3072 sc1 lds
nokv_7:
Lkvdone:
    s_add_u32 s48, s52, 720896
    s_add_u32 m0, s50, 57344
    s_nop 0
    buffer_load_dwordx4 v3, s[20:23], s48 offen lds
    s_add_u32 s48, s52, 737280
    s_add_u32 m0, s50, 59392
    s_nop 0
    buffer_load_dwordx4 v3, s[20:23], s48 offen lds
    s_add_u32 s48, s52, 753664
    s_add_u32 m0, s50, 61440
    s_nop 0
    buffer_load_dwordx4 v3, s[20:23], s48 offen lds
    s_waitcnt vmcnt(3)
    s_mov_b64 exec, 1
    s_add_u32 s47, s62, 16384
    buffer_store_dwordx2 v[24:25], v0, s[32:35], s47 offen sc1
    s_mov_b64 exec, -1
    s_branch Ljoin
Lnh1:
    s_add_u32 s48, s100, 1
    s_and_b32 s48, s48, 7
    s_mul_i32 s96, s48, 196608
    s_lshl_b32 s97, s48, 7
    s_add_u32 m0, s45, 86016
    s_nop 0
    buffer_load_dwordx4 v1, s[8:11], s97 offen lds
    s_add_u32 m0, s45, 87040
    s_nop 0
    buffer_load_dwordx4 v2, s[8:11], s97 offen lds
    s_add_u32 s48, s96, 0
    s_add_u32 m0, s46, 110592
    s_nop 0
    buffer_load_dwordx4 v3, s[12:15], s48 offen lds
    v_and_b32 v10, 31, v0
    v_lshrrev_b32 v11, 5, v0
    v_bfe_u32 v12, v0, 1, 3
    v_xor_b32 v12, v12, v11
    v_lshlrev_b32 v12, 4, v12
    v_lshl_add_u32 v5, v10, 7, v12
    s_lshl_b32 s47, s43, 12
    v_add_u32 v5, s47, v5
    s_lshl_b32 s47, s43, 5
    v_xor_b32 v5, s47, v5
    s_xor_b32 s5, s46, 1024
    s_xor_b32 s6, s46, 2048
    s_xor_b32 s7, s46, 3072
    s_mov_b32 s4, s46
    v_lshrrev_b32 v13, 2, v0
    v_xor_b32 v13, v13, v0
    v_and_b32 v13, 4, v13
    v_and_b32 v14, 3, v0
    v_or_b32 v13, v13, v14
    v_cmp_eq_u32 vcc, 0, v13
    v_mov_b32 v14, s58
    s_nop 0
    v_cndmask_b32 v240, 0, v14, vcc
    v_cndmask_b32 v241, 0, v14, vcc
    v_cndmask_b32 v242, 0, v14, vcc
    v_cndmask_b32 v243, 0, v14, vcc
    v_xor_b32 v6, 32, v5
    v_xor_b32 v7, 64, v5
    v_xor_b32 v8, 0x60, v5
    v_bfe_u32 v12, v0, 2, 2
    v_lshlrev_b32 v22, 6, v12
    v_bfe_u32 v12, v0, 4, 1
    v_lshl_add_u32 v22, v12, 5, v22
    v_and_b32 v12, 3, v0
    v_lshl_add_u32 v22, v12, 3, v22
    v_lshl_add_u32 v9, v11, 9, v22
    v_lshlrev_b32 v21, 4, v0
    v_mov_b32 v23, 0
    v_lshlrev_b32 v12, 4, v11
    s_lshl_b32 s62, s59, 8
    s_lshl_b32 s47, s41, 4
    s_add_u32 s62, s62, s47
    s_lshl_b32 s47, s44, 3
    s_add_u32 s62, s62, s47
    s_setprio 2
    v_add_u32 v224, 57344, v5
    v_add_u32 v225, 57344, v6
    v_add_u32 v226, 57344, v7
    v_add_u32 v227, 57344, v8
    s_add_u32 s47, s4, 73728
    v_add_u32 v10, s47, v9
    s_add_u32 s47, s5, 73728
    v_add_u32 v11, s47, v9
    s_add_u32 s47, s6, 73728
    v_add_u32 v13, s47, v9
    s_add_u32 s47, s7, 73728
    v_add_u32 v14, s47, v9
    s_waitcnt vmcnt(3)
    s_barrier
    ds_read_b128 v[32:35], v224
    ds_read_b64_tr_b16 v[192:193], v10 offset:8192
    ds_read_b64_tr_b16 v[194:195], v10 offset:8448
    s_add_u32 s48, s100, 2
    s_and_b32 s48, s48, 7
    s_mul_i32 s96, s48, 196608
    s_lshl_b32 s97, s48, 7
    s_add_u32 m0, s45, 114688
    s_nop 0
    buffer_load_dwordx4 v1, s[8:11], s97 offen lds
    s_add_u32 m0, s45, 115712
    s_nop 0
    buffer_load_dwordx4 v2, s[8:11], s97 offen lds
    ds_read_b128 v[36:39], v225
    ds_read_b64_tr_b16 v[200:201], v11 offset:8192
    ds_read_b64_tr_b16 v[202:203], v11 offset:8448
    s_add_u32 s48, s96, 0
    s_add_u32 m0, s46, 139264
    s_nop 0
    buffer_load_dwordx4 v3, s[12:15], s48 offen lds
    s_add_u32 s48, s100, 3
    s_and_b32 s48, s48, 7
    s_mul_i32 s96, s48, 196608
    s_lshl_b32 s97, s48, 7
    s_add_u32 m0, s45, 0
    s_nop 0
    buffer_load_dwordx4 v1, s[8:11], s97 offen lds
    ds_read_b128 v[40:43], v226
    ds_read_b64_tr_b16 v[208:209], v13 offset:8192
    ds_read_b64_tr_b16 v[210:211], v13 offset:8448
    s_add_u32 m0, s45, 1024
    s_nop 0
    buffer_load_dwordx4 v2, s[8:11], s97 offen lds
    s_add_u32 s48, s96, 0
    s_add_u32 m0, s46, 24576
    s_nop 0
    buffer_load_dwordx4 v3, s[12:15], s48 offen lds
    s_waitcnt lgkmcnt(6)
    ds_read_b128 v[44:47], v227
    ds_read_b64_tr_b16 v[216:217], v14 offset:8192
    ds_read_b64_tr_b16 v[218:219], v14 offset:8448
    v_and_b32 v10, 31, v0
    v_lshrrev_b32 v11, 2, v12
    v_sub_u32 v10, v10, v11
    v_cmp_gt_i32 s[64:65], 0, v10
    v_cmp_gt_i32 s[66:67], 1, v10
    v_cmp_gt_i32 s[68:69], 2, v10
    v_cmp_gt_i32 s[70:71], 3, v10
    v_cmp_gt_i32 s[72:73], 8, v10
    v_cmp_gt_i32 s[74:75], 9, v10
    v_cmp_gt_i32 s[76:77], 10, v10
    v_cmp_gt_i32 s[78:79], 11, v10
    v_cmp_gt_i32 s[80:81], 16, v10
    v_cmp_gt_i32 s[82:83], 17, v10
    v_cmp_gt_i32 s[84:85], 18, v10
    v_cmp_gt_i32 s[86:87], 19, v10
    v_cmp_gt_i32 s[88:89], 24, v10
    v_cmp_gt_i32 s[90:91], 25, v10
    v_cmp_gt_i32 s[92:93], 26, v10
    v_cmp_gt_i32 s[94:95], 27, v10
    v_mov_b32 v13, 0xffff
    v_mov_b32 v14, 0xffff0000
    v_cndmask_b32 v232, 0, v13, s[64:65]
    v_cndmask_b32 v11, 0, v14, s[66:67]
    v_or_b32 v232, v232, v11
    v_cndmask_b32 v233, 0, v13, s[68:69]
    v_cndmask_b32 v11, 0, v14, s[70:71]
    v_or_b32 v233, v233, v11
    v_cndmask_b32 v234, 0, v13, s[72:73]
    v_cndmask_b32 v11, 0, v14, s[74:75]
    v_or_b32 v234, v234, v11
    v_cndmask_b32 v235, 0, v13, s[76:77]
    v_cndmask_b32 v11, 0, v14, s[78:79]
    v_or_b32 v235, v235, v11
    v_cndmask_b32 v236, 0, v13, s[80:81]
    v_cndmask_b32 v11, 0, v14, s[82:83]
    v_or_b32 v236, v236, v11
    v_cndmask_b32 v237, 0, v13, s[84:85]
    v_cndmask_b32 v11, 0, v14, s[86:87]
    v_or_b32 v237, v237, v11
    v_cndmask_b32 v238, 0, v13, s[88:89]
    v_cndmask_b32 v11, 0, v14, s[90:91]
    v_or_b32 v238, v238, v11
    v_cndmask_b32 v239, 0, v13, s[92:93]
    v_cndmask_b32 v11, 0, v14, s[94:95]
    v_or_b32 v239, v239, v11
    v_add_u32 v224, 86016, v5
    v_add_u32 v225, 86016, v6
    v_add_u32 v226, 86016, v7
    v_add_u32 v227, 86016, v8
    s_add_u32 s47, s4, 102400
    v_add_u32 v10, s47, v9
    s_add_u32 s47, s5, 102400
    v_add_u32 v11, s47, v9
    s_add_u32 s47, s6, 102400
    v_add_u32 v13, s47, v9
    s_add_u32 s47, s7, 102400
    v_add_u32 v14, s47, v9
    s_waitcnt vmcnt(6)
    s_barrier
    s_waitcnt lgkmcnt(6)
    v_mfma_f32_32x32x16_bf16 v[160:175], v[192:195], v[32:35], 0
    ds_read_b128 v[48:51], v224
    ds_read_b64_tr_b16 v[192:193], v10 offset:8192
    ds_read_b64_tr_b16 v[194:195], v10 offset:8448
    s_add_u32 s48, s100, 4
    s_and_b32 s48, s48, 7
    s_mul_i32 s96, s48, 196608
    s_lshl_b32 s97, s48, 7
    s_add_u32 m0, s45, 28672
    s_nop 0
    buffer_load_dwordx4 v1, s[8:11], s97 offen lds
    s_waitcnt lgkmcnt(6)
    v_mfma_f32_32x32x16_bf16 v[160:175], v[200:203], v[36:39], v[160:175]
    ds_read_b128 v[52:55], v225
    ds_read_b64_tr_b16 v[200:201], v11 offset:8192
    ds_read_b64_tr_b16 v[202:203], v11 offset:8448
    s_add_u32 m0, s45, 29696
    s_nop 0
    buffer_load_dwordx4 v2, s[8:11], s97 offen lds
    s_waitcnt lgkmcnt(6)
    v_mfma_f32_32x32x16_bf16 v[160:175], v[208:211], v[40:43], v[160:175]
    ds_read_b128 v[56:59], v226
    ds_read_b64_tr_b16 v[208:209], v13 offset:8192
    ds_read_b64_tr_b16 v[210:211], v13 offset:8448
    s_add_u32 s48, s96, 0
    s_add_u32 m0, s46, 53248
    s_nop 0
    buffer_load_dwordx4 v3, s[12:15], s48 offen lds
    s_waitcnt lgkmcnt(6)
    v_mfma_f32_32x32x16_bf16 v[160:175], v[216:219], v[44:47], v[160:175]
    v_mfma_f32_16x16x32_bf16 v[248:251], v[240:243], v[216:219], 0
    v_mfma_f32_16x16x32_bf16 v[28:31], v[240:243], v[32:35], 0
    v_mfma_f32_16x16x32_bf16 v[244:247], v[240:243], v[36:39], 0
    v_mfma_f32_16x16x32_bf16 v[28:31], v[240:243], v[40:43], v[28:31]
    v_mfma_f32_16x16x32_bf16 v[244:247], v[240:243], v[44:47], v[244:247]
    v_mfma_f32_4x4x4_16b_bf16 v[176:179], v[32:33], v[32:33], 0
    v_mfma_f32_4x4x4_16b_bf16 v[180:183], v[34:35], v[34:35], 0
    v_mfma_f32_4x4x4_16b_bf16 v[184:187], v[36:37], v[36:37], 0
    v_mfma_f32_4x4x4_16b_bf16 v[188:191], v[38:39], v[38:39], 0
    v_mfma_f32_4x4x4_16b_bf16 v[176:179], v[40:41], v[40:41], v[176:179]
    v_mfma_f32_4x4x4_16b_bf16 v[180:183], v[42:43], v[42:43], v[180:183]
    v_mfma_f32_4x4x4_16b_bf16 v[184:187], v[44:45], v[44:45], v[184:187]
    v_mfma_f32_4x4x4_16b_bf16 v[188:191], v[46:47], v[46:47], v[188:191]
    ds_read_b128 v[60:63], v227
    ds_read_b64_tr_b16 v[216:217], v14 offset:8192
    ds_read_b64_tr_b16 v[218:219], v14 offset:8448
    v_add_u32 v224, 114688, v5
    v_add_u32 v225, 114688, v6
    v_add_u32 v226, 114688, v7
    v_add_u32 v227, 114688, v8
    s_add_u32 s47, s4, 131072
    v_add_u32 v10, s47, v9
    s_add_u32 s47, s5, 131072
    v_add_u32 v11, s47, v9
    s_add_u32 s47, s6, 131072
    v_add_u32 v13, s47, v9
    s_add_u32 s47, s7, 131072
    v_add_u32 v14, s47, v9
    s_waitcnt vmcnt(6)
    s_barrier
    s_waitcnt lgkmcnt(6)
    v_mfma_f32_32x32x16_bf16 v[160:175], v[192:195], v[48:51], v[160:175]
    ds_read_b128 v[64:67], v224
    ds_read_b64_tr_b16 v[192:193], v10 offset:8192
    ds_read_b64_tr_b16 v[194:195], v10 offset:8448
    s_add_u32 s48, s100, 5
    s_and_b32 s48, s48, 7
    s_mul_i32 s96, s48, 196608
    s_lshl_b32 s97, s48, 7
    s_add_u32 m0, s45, 57344
    s_nop 0
    buffer_load_dwordx4 v1, s[8:11], s97 offen lds
    s_waitcnt lgkmcnt(6)
    v_mfma_f32_32x32x16_bf16 v[160:175], v[200:203], v[52:55], v[160:175]
    ds_read_b128 v[68:71], v225
    ds_read_b64_tr_b16 v[200:201], v11 offset:8192
    ds_read_b64_tr_b16 v[202:203], v11 offset:8448
    s_add_u32 m0, s45, 58368
    s_nop 0
    buffer_load_dwordx4 v2, s[8:11], s97 offen lds
    s_waitcnt lgkmcnt(6)
    v_mfma_f32_32x32x16_bf16 v[160:175], v[208:211], v[56:59], v[160:175]
    ds_read_b128 v[72:75], v226
    ds_read_b64_tr_b16 v[208:209], v13 offset:8192
    ds_read_b64_tr_b16 v[210:211], v13 offset:8448
    s_add_u32 s48, s96, 0
    s_add_u32 m0, s46, 81920
    s_nop 0
    buffer_load_dwordx4 v3, s[12:15], s48 offen lds
    s_waitcnt lgkmcnt(6)
    v_mfma_f32_32x32x16_bf16 v[160:175], v[216:219], v[60:63], v[160:175]
    v_mfma_f32_16x16x32_bf16 v[248:251], v[240:243], v[216:219], v[248:251]
    v_mfma_f32_16x16x32_bf16 v[28:31], v[240:243], v[48:51], v[28:31]
    v_mfma_f32_16x16x32_bf16 v[244:247], v[240:243], v[52:55], v[244:247]
    v_mfma_f32_16x16x32_bf16 v[28:31], v[240:243], v[56:59], v[28:31]
    v_mfma_f32_16x16x32_bf16 v[244:247], v[240:243], v[60:63], v[244:247]
    v_mfma_f32_4x4x4_16b_bf16 v[176:179], v[48:49], v[48:49], v[176:179]
    v_mfma_f32_4x4x4_16b_bf16 v[180:183], v[50:51], v[50:51], v[180:183]
    v_mfma_f32_4x4x4_16b_bf16 v[184:187], v[52:53], v[52:53], v[184:187]
    v_mfma_f32_4x4x4_16b_bf16 v[188:191], v[54:55], v[54:55], v[188:191]
    v_mfma_f32_4x4x4_16b_bf16 v[176:179], v[56:57], v[56:57], v[176:179]
    v_mfma_f32_4x4x4_16b_bf16 v[180:183], v[58:59], v[58:59], v[180:183]
    v_mfma_f32_4x4x4_16b_bf16 v[184:187], v[60:61], v[60:61], v[184:187]
    v_mfma_f32_4x4x4_16b_bf16 v[188:191], v[62:63], v[62:63], v[188:191]
    ds_read_b128 v[76:79], v227
    ds_read_b64_tr_b16 v[216:217], v14 offset:8192
    ds_read_b64_tr_b16 v[218:219], v14 offset:8448
    v_add_u32 v224, 0, v5
    v_add_u32 v225, 0, v6
    v_add_u32 v226, 0, v7
    v_add_u32 v227, 0, v8
    s_add_u32 s47, s4, 16384
    v_add_u32 v10, s47, v9
    s_add_u32 s47, s5, 16384
    v_add_u32 v11, s47, v9
    s_add_u32 s47, s6, 16384
    v_add_u32 v13, s47, v9
    s_add_u32 s47, s7, 16384
    v_add_u32 v14, s47, v9
    s_waitcnt vmcnt(6)
    s_barrier
    s_waitcnt lgkmcnt(6)
    v_mfma_f32_32x32x16_bf16 v[160:175], v[192:195], v[64:67], v[160:175]
    ds_read_b128 v[80:83], v224
    ds_read_b64_tr_b16 v[192:193], v10 offset:8192
    ds_read_b64_tr_b16 v[194:195], v10 offset:8448
    s_add_u32 s48, s100, 6
    s_and_b32 s48, s48, 7
    s_mul_i32 s96, s48, 196608
    s_lshl_b32 s97, s48, 7
    s_add_u32 m0, s45, 86016
    s_nop 0
    buffer_load_dwordx4 v1, s[8:11], s97 offen lds
    s_waitcnt lgkmcnt(6)
    v_mfma_f32_32x32x16_bf16 v[160:175], v[200:203], v[68:71], v[160:175]
    ds_read_b128 v[84:87], v225
    ds_read_b64_tr_b16 v[200:201], v11 offset:8192
    ds_read_b64_tr_b16 v[202:203], v11 offset:8448
    s_add_u32 m0, s45, 87040
    s_nop 0
    buffer_load_dwordx4 v2, s[8:11], s97 offen lds
    s_waitcnt lgkmcnt(6)
    v_mfma_f32_32x32x16_bf16 v[160:175], v[208:211], v[72:75], v[160:175]
    ds_read_b128 v[88:91], v226
    ds_read_b64_tr_b16 v[208:209], v13 offset:8192
    ds_read_b64_tr_b16 v[210:211], v13 offset:8448
    s_add_u32 s48, s96, 0
    s_add_u32 m0, s46, 110592
    s_nop 0
    buffer_load_dwordx4 v3, s[12:15], s48 offen lds
    s_waitcnt lgkmcnt(6)
    v_mfma_f32_32x32x16_bf16 v[160:175], v[216:219], v[76:79], v[160:175]
    v_mfma_f32_16x16x32_bf16 v[248:251], v[240:243], v[216:219], v[248:251]
    v_mfma_f32_16x16x32_bf16 v[28:31], v[240:243], v[64:67], v[28:31]
    v_mfma_f32_16x16x32_bf16 v[244:247], v[240:243], v[68:71], v[244:247]
    v_mfma_f32_16x16x32_bf16 v[28:31], v[240:243], v[72:75], v[28:31]
    v_mfma_f32_16x16x32_bf16 v[244:247], v[240:243], v[76:79], v[244:247]
    v_mfma_f32_4x4x4_16b_bf16 v[176:179], v[64:65], v[64:65], v[176:179]
    v_mfma_f32_4x4x4_16b_bf16 v[180:183], v[66:67], v[66:67], v[180:183]
    v_mfma_f32_4x4x4_16b_bf16 v[184:187], v[68:69], v[68:69], v[184:187]
    v_mfma_f32_4x4x4_16b_bf16 v[188:191], v[70:71], v[70:71], v[188:191]
    v_mfma_f32_4x4x4_16b_bf16 v[176:179], v[72:73], v[72:73], v[176:179]
    v_mfma_f32_4x4x4_16b_bf16 v[180:183], v[74:75], v[74:75], v[180:183]
    v_mfma_f32_4x4x4_16b_bf16 v[184:187], v[76:77], v[76:77], v[184:187]
    v_mfma_f32_4x4x4_16b_bf16 v[188:191], v[78:79], v[78:79], v[188:191]
    ds_read_b128 v[92:95], v227
    ds_read_b64_tr_b16 v[216:217], v14 offset:8192
    ds_read_b64_tr_b16 v[218:219], v14 offset:8448
    v_add_u32 v224, 28672, v5
    v_add_u32 v225, 28672, v6
    v_add_u32 v226, 28672, v7
    v_add_u32 v227, 28672, v8
    s_add_u32 s47, s4, 45056
    v_add_u32 v10, s47, v9
    s_add_u32 s47, s5, 45056
    v_add_u32 v11, s47, v9
    s_add_u32 s47, s6, 45056
    v_add_u32 v13, s47, v9
    s_add_u32 s47, s7, 45056
    v_add_u32 v14, s47, v9
    s_mul_i32 s47, s41, 192
    s_mul_i32 s3, s43, 44032
    s_add_u32 s47, s47, s3
    s_mul_i32 s3, s46, 3
    v_add_u32 v26, 0, v0
    v_mul_u32_u24 v27, 43691, v26
    v_lshrrev_b32 v27, 19, v27
    v_lshlrev_b32 v26, 4, v26
    v_mul_u32_u24 v27, 2560, v27
    v_add3_u32 v4, v26, v27, s47
    v_add_u32 v26, 64, v0
    v_mul_u32_u24 v27, 43691, v26
    v_lshrrev_b32 v27, 19, v27
    v_lshlrev_b32 v26, 4, v26
    v_mul_u32_u24 v27, 2560, v27
    v_add3_u32 v19, v26, v27, s47
    v_add_u32 v26, 128, v0
    v_mul_u32_u24 v27, 43691, v26
    v_lshrrev_b32 v27, 19, v27
    v_lshlrev_b32 v26, 4, v26
    v_mul_u32_u24 v27, 2560, v27
    v_add3_u32 v20, v26, v27, s47
    v_bfe_u32 v26, v0, 2, 2
    v_lshlrev_b32 v26, 7, v26
    v_add_u32 v22, v22, v26
    v_mul_u32_u24 v26, 96, v12
    v_add_u32 v22, v22, v26
    s_waitcnt vmcnt(6)
    s_barrier
    s_waitcnt lgkmcnt(6)
    v_mfma_f32_32x32x16_bf16 v[160:175], v[192:195], v[80:83], v[160:175]
    ds_read_b128 v[96:99], v224
    ds_read_b64_tr_b16 v[192:193], v10 offset:8192
    ds_read_b64_tr_b16 v[194:195], v10 offset:8448
    s_add_u32 s48, s100, 7
    s_and_b32 s48, s48, 7
    s_mul_i32 s96, s48, 196608
    s_lshl_b32 s97, s48, 7
    s_add_u32 m0, s45, 114688
    s_nop 0
    buffer_load_dwordx4 v1, s[8:11], s97 offen lds
    s_waitcnt lgkmcnt(6)
    v_mfma_f32_32x32x16_bf16 v[160:175], v[200:203], v[84:87], v[160:175]
    ds_read_b128 v[100:103], v225
    ds_read_b64_tr_b16 v[200:201], v11 offset:8192
    ds_read_b64_tr_b16 v[202:203], v11 offset:8448
    s_add_u32 m0, s45, 115712
    s_nop 0
    buffer_load_dwordx4 v2, s[8:11], s97 offen lds
    s_waitcnt lgkmcnt(6)
    v_mfma_f32_32x32x16_bf16 v[160:175], v[208:211], v[88:91], v[160:175]
    ds_read_b128 v[104:107], v226
    ds_read_b64_tr_b16 v[208:209], v13 offset:8192
    ds_read_b64_tr_b16 v[210:211], v13 offset:8448
    s_add_u32 s48, s96, 0
    s_add_u32 m0, s46, 139264
    s_nop 0
    buffer_load_dwordx4 v3, s[12:15], s48 offen lds
    s_waitcnt lgkmcnt(6)
    v_mfma_f32_32x32x16_bf16 v[160:175], v[216:219], v[92:95], v[160:175]
    v_mfma_f32_16x16x32_bf16 v[248:251], v[240:243], v[216:219], v[248:251]
    v_mfma_f32_16x16x32_bf16 v[28:31], v[240:243], v[80:83], v[28:31]
    v_mfma_f32_16x16x32_bf16 v[244:247], v[240:243], v[84:87], v[244:247]
    v_mfma_f32_16x16x32_bf16 v[28:31], v[240:243], v[88:91], v[28:31]
    v_mfma_f32_16x16x32_bf16 v[244:247], v[240:243], v[92:95], v[244:247]
    v_mfma_f32_4x4x4_16b_bf16 v[176:179], v[80:81], v[80:81], v[176:179]
    v_mfma_f32_4x4x4_16b_bf16 v[180:183], v[82:83], v[82:83], v[180:183]
    v_mfma_f32_4x4x4_16b_bf16 v[184:187], v[84:85], v[84:85], v[184:187]
    v_mfma_f32_4x4x4_16b_bf16 v[188:191], v[86:87], v[86:87], v[188:191]
    v_mfma_f32_4x4x4_16b_bf16 v[176:179], v[88:89], v[88:89], v[176:179]
    v_mfma_f32_4x4x4_16b_bf16 v[180:183], v[90:91], v[90:91], v[180:183]
    v_mfma_f32_4x4x4_16b_bf16 v[184:187], v[92:93], v[92:93], v[184:187]
    v_mfma_f32_4x4x4_16b_bf16 v[188:191], v[94:95], v[94:95], v[188:191]
    ds_read_b128 v[108:111], v227
    ds_read_b64_tr_b16 v[216:217], v14 offset:8192
    ds_read_b64_tr_b16 v[218:219], v14 offset:8448
    v_add_u32 v224, 57344, v5
    v_add_u32 v225, 57344, v6
    v_add_u32 v226, 57344, v7
    v_add_u32 v227, 57344, v8
    s_add_u32 s47, s4, 73728
    v_add_u32 v10, s47, v9
    s_add_u32 s47, s5, 73728
    v_add_u32 v11, s47, v9
    s_add_u32 s47, s6, 73728
    v_add_u32 v13, s47, v9
    s_add_u32 s47, s7, 73728
    v_add_u32 v14, s47, v9
    buffer_load_dwordx2 v[24:25], v23, s[36:39], 0 offen sc1
    s_waitcnt vmcnt(7)
    s_barrier
    s_waitcnt lgkmcnt(6)
    v_mfma_f32_32x32x16_bf16 v[160:175], v[192:195], v[96:99], v[160:175]
    ds_read_b128 v[112:115], v224
    ds_read_b64_tr_b16 v[192:193], v10 offset:8192
    ds_read_b64_tr_b16 v[194:195], v10 offset:8448
    s_add_u32 s96, s100, 1
    s_and_b32 s96, s96, 7
    s_mul_i32 s96, s96, 176128
    s_add_u32 m0, s3, 12288
    s_nop 0
    buffer_load_dwordx4 v4, s[16:19], s96 offen lds
    s_waitcnt lgkmcnt(6)
    v_mfma_f32_32x32x16_bf16 v[160:175], v[200:203], v[100:103], v[160:175]
    ds_read_b128 v[116:119], v225
    ds_read_b64_tr_b16 v[200:201], v11 offset:8192
    ds_read_b64_tr_b16 v[202:203], v11 offset:8448
    s_add_u32 m0, s3, 13312
    s_nop 0
    buffer_load_dwordx4 v19, s[16:19], s96 offen lds
    s_waitcnt lgkmcnt(6)
    v_mfma_f32_32x32x16_bf16 v[160:175], v[208:211], v[104:107], v[160:175]
    ds_read_b128 v[120:123], v226
    ds_read_b64_tr_b16 v[208:209], v13 offset:8192
    ds_read_b64_tr_b16 v[210:211], v13 offset:8448
    s_add_u32 m0, s3, 14336
    s_nop 0
    buffer_load_dwordx4 v20, s[16:19], s96 offen lds
    s_waitcnt lgkmcnt(6)
    v_mfma_f32_32x32x16_bf16 v[160:175], v[216:219], v[108:111], v[160:175]
    v_mfma_f32_16x16x32_bf16 v[248:251], v[240:243], v[216:219], v[248:251]
    v_mfma_f32_16x16x32_bf16 v[28:31], v[240:243], v[96:99], v[28:31]
    v_mfma_f32_16x16x32_bf16 v[244:247], v[240:243], v[100:103], v[244:247]
    v_mfma_f32_16x16x32_bf16 v[28:31], v[240:243], v[104:107], v[28:31]
    v_mfma_f32_16x16x32_bf16 v[244:247], v[240:243], v[108:111], v[244:247]
    v_mfma_f32_4x4x4_16b_bf16 v[176:179], v[96:97], v[96:97], v[176:179]
    v_mfma_f32_4x4x4_16b_bf16 v[180:183], v[98:99], v[98:99], v[180:183]
    v_mfma_f32_4x4x4_16b_bf16 v[184:187], v[100:101], v[100:101], v[184:187]
    v_mfma_f32_4x4x4_16b_bf16 v[188:191], v[102:103], v[102:103], v[188:191]
    v_mfma_f32_4x4x4_16b_bf16 v[176:179], v[104:105], v[104:105], v[176:179]
    v_mfma_f32_4x4x4_16b_bf16 v[180:183], v[106:107], v[106:107], v[180:183]
    v_mfma_f32_4x4x4_16b_bf16 v[184:187], v[108:109], v[108:109], v[184:187]
    v_mfma_f32_4x4x4_16b_bf16 v[188:191], v[110:111], v[110:111], v[188:191]
    ds_read_b128 v[124:127], v227
    ds_read_b64_tr_b16 v[216:217], v14 offset:8192
    ds_read_b64_tr_b16 v[218:219], v14 offset:8448
    v_add_u32 v224, 86016, v5
    v_add_u32 v225, 86016, v6
    v_add_u32 v226, 86016, v7
    v_add_u32 v227, 86016, v8
    s_add_u32 s47, s4, 102400
    v_add_u32 v10, s47, v9
    s_add_u32 s47, s5, 102400
    v_add_u32 v11, s47, v9
    s_add_u32 s47, s6, 102400
    v_add_u32 v13, s47, v9
    s_add_u32 s47, s7, 102400
    v_add_u32 v14, s47, v9
    s_waitcnt vmcnt(7)
    s_barrier
    s_waitcnt lgkmcnt(6)
    v_mfma_f32_32x32x16_bf16 v[160:175], v[192:195], v[112:115], v[160:175]
    ds_read_b128 v[128:131], v224
    ds_read_b64_tr_b16 v[192:193], v10 offset:8192
    ds_read_b64_tr_b16 v[194:195], v10 offset:8448
    s_add_u32 s96, s100, 3
    s_and_b32 s96, s96, 7
    s_mul_i32 s96, s96, 176128
    s_add_u32 m0, s3, 40960
    s_nop 0
    buffer_load_dwordx4 v4, s[16:19], s96 offen lds
    s_waitcnt lgkmcnt(6)
    v_mfma_f32_32x32x16_bf16 v[160:175], v[200:203], v[116:119], v[160:175]
    ds_read_b128 v[132:135], v225
    ds_read_b64_tr_b16 v[200:201], v11 offset:8192
    ds_read_b64_tr_b16 v[202:203], v11 offset:8448
    s_add_u32 m0, s3, 41984
    s_nop 0
    buffer_load_dwordx4 v19, s[16:19], s96 offen lds
    s_waitcnt lgkmcnt(6)
    v_mfma_f32_32x32x16_bf16 v[160:175], v[208:211], v[120:123], v[160:175]
    ds_read_b128 v[136:139], v226
    ds_read_b64_tr_b16 v[208:209], v13 offset:8192
    ds_read_b64_tr_b16 v[210:211], v13 offset:8448
    s_add_u32 m0, s3, 43008
    s_nop 0
    buffer_load_dwordx4 v20, s[16:19], s96 offen lds
    s_waitcnt lgkmcnt(6)
    v_mfma_f32_32x32x16_bf16 v[160:175], v[216:219], v[124:127], v[160:175]
    v_mfma_f32_16x16x32_bf16 v[248:251], v[240:243], v[216:219], v[248:251]
    v_mfma_f32_16x16x32_bf16 v[28:31], v[240:243], v[112:115], v[28:31]
    v_mfma_f32_16x16x32_bf16 v[244:247], v[240:243], v[116:119], v[244:247]
    v_mfma_f32_16x16x32_bf16 v[28:31], v[240:243], v[120:123], v[28:31]
    v_mfma_f32_16x16x32_bf16 v[244:247], v[240:243], v[124:127], v[244:247]
    v_mfma_f32_4x4x4_16b_bf16 v[176:179], v[112:113], v[112:113], v[176:179]
    v_mfma_f32_4x4x4_16b_bf16 v[180:183], v[114:115], v[114:115], v[180:183]
    v_mfma_f32_4x4x4_16b_bf16 v[184:187], v[116:117], v[116:117], v[184:187]
    v_mfma_f32_4x4x4_16b_bf16 v[188:191], v[118:119], v[118:119], v[188:191]
    v_mfma_f32_4x4x4_16b_bf16 v[176:179], v[120:121], v[120:121], v[176:179]
    v_mfma_f32_4x4x4_16b_bf16 v[180:183], v[122:123], v[122:123], v[180:183]
    v_mfma_f32_4x4x4_16b_bf16 v[184:187], v[124:125], v[124:125], v[184:187]
    v_mfma_f32_4x4x4_16b_bf16 v[188:191], v[126:127], v[126:127], v[188:191]
    ds_read_b128 v[140:143], v227
    ds_read_b64_tr_b16 v[216:217], v14 offset:8192
    ds_read_b64_tr_b16 v[218:219], v14 offset:8448
    v_add_u32 v224, 114688, v5
    v_add_u32 v225, 114688, v6
    v_add_u32 v226, 114688, v7
    v_add_u32 v227, 114688, v8
    s_add_u32 s47, s4, 131072
    v_add_u32 v10, s47, v9
    s_add_u32 s47, s5, 131072
    v_add_u32 v11, s47, v9
    s_add_u32 s47, s6, 131072
    v_add_u32 v13, s47, v9
    s_add_u32 s47, s7, 131072
    v_add_u32 v14, s47, v9
    s_waitcnt vmcnt(7)
    s_barrier
    s_waitcnt lgkmcnt(6)
    v_mfma_f32_32x32x16_bf16 v[160:175], v[192:195], v[128:131], v[160:175]
    ds_read_b128 v[144:147], v224
    ds_read_b64_tr_b16 v[192:193], v10 offset:8192
    ds_read_b64_tr_b16 v[194:195], v10 offset:8448
    s_add_u32 s96, s100, 5
    s_and_b32 s96, s96, 7
    s_mul_i32 s96, s96, 176128
    s_add_u32 m0, s3, 69632
    s_nop 0
    buffer_load_dwordx4 v4, s[16:19], s96 offen lds
    s_waitcnt lgkmcnt(6)
    v_mfma_f32_32x32x16_bf16 v[160:175], v[200:203], v[132:135], v[160:175]
    ds_read_b128 v[148:151], v225
    ds_read_b64_tr_b16 v[200:201], v11 offset:8192
    ds_read_b64_tr_b16 v[202:203], v11 offset:8448
    s_add_u32 m0, s3, 70656
    s_nop 0
    buffer_load_dwordx4 v19, s[16:19], s96 offen lds
    s_waitcnt lgkmcnt(6)
    v_mfma_f32_32x32x16_bf16 v[160:175], v[208:211], v[136:139], v[160:175]
    ds_read_b128 v[152:155], v226
    ds_read_b64_tr_b16 v[208:209], v13 offset:8192
    ds_read_b64_tr_b16 v[210:211], v13 offset:8448
    s_add_u32 m0, s3, 71680
    s_nop 0
    buffer_load_dwordx4 v20, s[16:19], s96 offen lds
    s_waitcnt lgkmcnt(6)
    v_mfma_f32_32x32x16_bf16 v[160:175], v[216:219], v[140:143], v[160:175]
    v_mfma_f32_16x16x32_bf16 v[248:251], v[240:243], v[216:219], v[248:251]
    v_mfma_f32_16x16x32_bf16 v[28:31], v[240:243], v[128:131], v[28:31]
    v_mfma_f32_16x16x32_bf16 v[244:247], v[240:243], v[132:135], v[244:247]
    v_mfma_f32_16x16x32_bf16 v[28:31], v[240:243], v[136:139], v[28:31]
    v_mfma_f32_16x16x32_bf16 v[244:247], v[240:243], v[140:143], v[244:247]
    v_mfma_f32_4x4x4_16b_bf16 v[176:179], v[128:129], v[128:129], v[176:179]
    v_mfma_f32_4x4x4_16b_bf16 v[180:183], v[130:131], v[130:131], v[180:183]
    v_mfma_f32_4x4x4_16b_bf16 v[184:187], v[132:133], v[132:133], v[184:187]
    v_mfma_f32_4x4x4_16b_bf16 v[188:191], v[134:135], v[134:135], v[188:191]
    v_mfma_f32_4x4x4_16b_bf16 v[176:179], v[136:137], v[136:137], v[176:179]
    v_mfma_f32_4x4x4_16b_bf16 v[180:183], v[138:139], v[138:139], v[180:183]
    v_mfma_f32_4x4x4_16b_bf16 v[184:187], v[140:141], v[140:141], v[184:187]
    v_mfma_f32_4x4x4_16b_bf16 v[188:191], v[142:143], v[142:143], v[188:191]
    ds_read_b128 v[156:159], v227
    ds_read_b64_tr_b16 v[216:217], v14 offset:8192
    ds_read_b64_tr_b16 v[218:219], v14 offset:8448
    s_waitcnt lgkmcnt(6)
    v_mfma_f32_32x32x16_bf16 v[160:175], v[192:195], v[144:147], v[160:175]
    s_waitcnt lgkmcnt(6)
    v_mfma_f32_32x32x16_bf16 v[160:175], v[200:203], v[148:151], v[160:175]
    s_waitcnt lgkmcnt(3)
    v_mfma_f32_32x32x16_bf16 v[160:175], v[208:211], v[152:155], v[160:175]
    s_waitcnt lgkmcnt(0)
    v_mfma_f32_32x32x16_bf16 v[160:175], v[216:219], v[156:159], v[160:175]
    v_mfma_f32_16x16x32_bf16 v[248:251], v[240:243], v[216:219], v[248:251]
    v_mfma_f32_16x16x32_bf16 v[28:31], v[240:243], v[144:147], v[28:31]
    v_mfma_f32_16x16x32_bf16 v[244:247], v[240:243], v[148:151], v[244:247]
    v_mfma_f32_16x16x32_bf16 v[28:31], v[240:243], v[152:155], v[28:31]
    v_mfma_f32_16x16x32_bf16 v[244:247], v[240:243], v[156:159], v[244:247]
    v_mfma_f32_4x4x4_16b_bf16 v[176:179], v[144:145], v[144:145], v[176:179]
    v_mfma_f32_4x4x4_16b_bf16 v[180:183], v[146:147], v[146:147], v[180:183]
    v_mfma_f32_4x4x4_16b_bf16 v[184:187], v[148:149], v[148:149], v[184:187]
    v_mfma_f32_4x4x4_16b_bf16 v[188:191], v[150:151], v[150:151], v[188:191]
    v_mfma_f32_4x4x4_16b_bf16 v[176:179], v[152:153], v[152:153], v[176:179]
    v_mfma_f32_4x4x4_16b_bf16 v[180:183], v[154:155], v[154:155], v[180:183]
    v_mfma_f32_4x4x4_16b_bf16 v[184:187], v[156:157], v[156:157], v[184:187]
    v_mfma_f32_4x4x4_16b_bf16 v[188:191], v[158:159], v[158:159], v[188:191]
    v_and_b32 v10, 31, v0
    v_lshlrev_b32 v10, 4, v10
    s_lshl_b32 s47, s43, 2
    v_add_u32 v11, s47, v10
    v_cvt_pk_bf16_f32 v249, v248, v248
    v_lshlrev_b32 v249, 16, v249
    v_sub_f32 v249, v248, v249
    v_cvt_pk_bf16_f32 v250, v248, v249
    ds_write_b32 v11, v250 offset:25600
    v_lshrrev_b32 v13, 2, v10
    s_lshl_b32 s47, s43, 7
    v_add_u32 v13, s47, v13
    v_lshl_add_u32 v14, v12, 5, v13
    v_add_f32 v28, v28, v244
    v_add_f32 v176, v176, v184
    v_add_f32 v177, v177, v185
    v_add_f32 v178, v178, v186
    v_add_f32 v179, v179, v187
    v_add_f32 v180, v180, v188
    v_add_f32 v181, v181, v189
    v_add_f32 v182, v182, v190
    v_add_f32 v183, v183, v191
    v_add_f32 v15, v176, v180
    v_add_f32 v16, v177, v181
    v_add_f32 v17, v178, v182
    v_add_f32 v18, v179, v183
    v_and_b32 v27, 1, v0
    v_cmp_eq_u32 vcc, 0, v27
    v_and_b32 v27, 2, v0
    s_nop 0
    v_cndmask_b32 v15, v16, v15, vcc
    v_cndmask_b32 v17, v18, v17, vcc
    v_cmp_eq_u32 vcc, 0, v27
    s_nop 1
    v_cndmask_b32 v17, v17, v15, vcc
    v_mov_b32 v18, v17
    v_mul_f32 v15, 0xbb000000, v28
    s_nop 0
    v_permlane32_swap_b32 v17, v18
    v_add_f32 v17, v17, v18
    v_mul_f32 v17, 0x3b000000, v17
    v_fma_f32 v17, -v15, v15, v17
    v_max_f32 v17, 0, v17
    v_add_f32 v17, 0x3727c5ac, v17
    v_rsq_f32 v26, v17
    v_cvt_pk_bf16_f32 v16, v15, v15
    v_lshlrev_b32 v16, 16, v16
    v_sub_f32 v16, v15, v16
    v_cmp_lt_u32 vcc, 31, v0
    s_nop 1
    v_cndmask_b32 v15, v15, v16, vcc
    v_cvt_pk_bf16_f32 v27, v15, v15
    ds_write_b32 v13, v26 offset:53248
    ds_write_b32 v14, v27 offset:53760
    s_waitcnt vmcnt(9)
    s_mov_b32 s47, 0x40000
np_8:
    v_readfirstlane_b32 s56, v24
    v_readfirstlane_b32 s57, v25
    s_cmp_lg_u32 s56, 0
    s_cbranch_scc1 nd_9
    s_sub_u32 s47, s47, 1
    s_cbranch_scc1 nd_9
    s_sleep 1
    buffer_load_dwordx2 v[24:25], v23, s[36:39], 0 offen sc1
    s_waitcnt vmcnt(0)
    s_branch np_8
nd_9:
    s_waitcnt lgkmcnt(0)
    s_setprio 0
    s_barrier
    s_add_u32 s96, s100, 7
    s_and_b32 s96, s96, 7
    s_mul_i32 s96, s96, 176128
    s_add_u32 m0, s3, 98304
    s_nop 0
    buffer_load_dwordx4 v4, s[16:19], s96 offen lds
    s_add_u32 m0, s3, 99328
    s_nop 0
    buffer_load_dwordx4 v19, s[16:19], s96 offen lds
    s_add_u32 m0, s3, 100352
    s_nop 0
    buffer_load_dwordx4 v20, s[16:19], s96 offen lds
    ds_read_b128 v[192:195], v10 offset:25600
    v_mov_b32 v244, v27
    v_mov_b32 v245, v27
    v_mov_b32 v246, v27
    v_mov_b32 v247, v27
    v_mov_b32 v15, s58
    v_lshlrev_b32 v16, 2, v0
    s_lshr_b32 s47, s46, 2
    s_add_u32 s47, s47, 110592
    v_add_u32 v16, s47, v16
    ds_write_b32 v16, v15
    v_mul_f32 v13, 0x3eb8aa3b, v26
    s_add_u32 s47, s46, 81920
    v_add_u32 v11, s47, v21
    v_mul_f32 v19, 0xbfb8aa3b, v26
    v_rcp_f32 v20, v26
    s_waitcnt lgkmcnt(1)
    v_mfma_f32_32x32x16_bf16 v[160:175], v[192:195], v[244:247], v[160:175]
    s_mul_i32 s47, s4, 3
    s_add_u32 s47, s47, 0
    v_add_u32 v15, s47, v22
    s_mul_i32 s47, s5, 3
    s_add_u32 s47, s47, 0
    v_add_u32 v16, s47, v22
    s_mul_i32 s47, s6, 3
    s_add_u32 s47, s47, 0
    v_add_u32 v17, s47, v22
    s_mul_i32 s47, s7, 3
    s_add_u32 s47, s47, 0
    v_add_u32 v18, s47, v22
    ds_read_b64_tr_b16 v[196:197], v15 offset:64
    ds_read_b64_tr_b16 v[198:199], v15 offset:832
    ds_read_b64_tr_b16 v[200:201], v15 offset:128
    ds_read_b64_tr_b16 v[202:203], v15 offset:896
    ds_read_b64_tr_b16 v[204:205], v16 offset:64
    ds_read_b64_tr_b16 v[206:207], v16 offset:832
    ds_read_b64_tr_b16 v[208:209], v16 offset:128
    ds_read_b64_tr_b16 v[210:211], v16 offset:896
    ds_read_b64_tr_b16 v[212:213], v17 offset:64
    ds_read_b64_tr_b16 v[214:215], v17 offset:832
    ds_read_b64_tr_b16 v[216:217], v17 offset:128
    ds_read_b64_tr_b16 v[218:219], v17 offset:896
    v_mul_f32 v160, v13, v160
    v_mul_f32 v161, v13, v161
    v_mul_f32 v162, v13, v162
    v_mul_f32 v163, v13, v163
    v_mul_f32 v164, v13, v164
    v_mul_f32 v165, v13, v165
    v_mul_f32 v166, v13, v166
    v_mul_f32 v167, v13, v167
    v_mul_f32 v168, v13, v168
    v_mul_f32 v169, v13, v169
    v_mul_f32 v170, v13, v170
    v_mul_f32 v171, v13, v171
    v_mul_f32 v172, v13, v172
    v_mul_f32 v173, v13, v173
    v_mul_f32 v174, v13, v174
    v_mul_f32 v175, v13, v175
    v_cvt_pk_bf16_f32 v192, v160, v161
    v_cvt_pk_bf16_f32 v193, v162, v163
    v_cvt_pk_bf16_f32 v194, v164, v165
    v_cvt_pk_bf16_f32 v195, v166, v167
    v_cvt_pk_bf16_f32 v28, v168, v169
    v_cvt_pk_bf16_f32 v29, v170, v171
    v_cvt_pk_bf16_f32 v30, v172, v173
    v_cvt_pk_bf16_f32 v31, v174, v175
    ds_write_b128 v11, v[192:195]
    s_waitcnt lgkmcnt(0)
    s_waitcnt lgkmcnt(8)
    v_mfma_f32_32x32x16_bf16 v[160:175], v[196:199], v[32:35], 0
    v_mfma_f32_32x32x16_bf16 v[176:191], v[200:203], v[32:35], 0
    ds_read_b64_tr_b16 v[220:221], v18 offset:64
    ds_read_b64_tr_b16 v[222:223], v18 offset:832
    ds_read_b64_tr_b16 v[224:225], v18 offset:128
    ds_read_b64_tr_b16 v[226:227], v18 offset:896
    v_mfma_f32_16x16x32_bf16 v[248:251], v[240:243], v[196:199], 0
    v_mfma_f32_16x16x32_bf16 v[192:195], v[240:243], v[200:203], 0
    s_waitcnt lgkmcnt(8)
    v_mfma_f32_32x32x16_bf16 v[160:175], v[204:207], v[36:39], v[160:175]
    v_mfma_f32_32x32x16_bf16 v[176:191], v[208:211], v[36:39], v[176:191]
    ds_read_b64_tr_b16 v[196:197], v15 offset:12352
    ds_read_b64_tr_b16 v[198:199], v15 offset:13120
    ds_read_b64_tr_b16 v[200:201], v15 offset:12416
    ds_read_b64_tr_b16 v[202:203], v15 offset:13184
    s_waitcnt lgkmcnt(8)
    v_mfma_f32_32x32x16_bf16 v[160:175], v[212:215], v[40:43], v[160:175]
    v_mfma_f32_32x32x16_bf16 v[176:191], v[216:219], v[40:43], v[176:191]
    ds_read_b64_tr_b16 v[204:205], v16 offset:12352
    ds_read_b64_tr_b16 v[206:207], v16 offset:13120
    ds_read_b64_tr_b16 v[208:209], v16 offset:12416
    ds_read_b64_tr_b16 v[210:211], v16 offset:13184
    s_waitcnt lgkmcnt(8)
    v_mfma_f32_32x32x16_bf16 v[160:175], v[220:223], v[44:47], v[160:175]
    v_mfma_f32_32x32x16_bf16 v[176:191], v[224:227], v[44:47], v[176:191]
    ds_read_b64_tr_b16 v[212:213], v17 offset:12352
    ds_read_b64_tr_b16 v[214:215], v17 offset:13120
    ds_read_b64_tr_b16 v[216:217], v17 offset:12416
    ds_read_b64_tr_b16 v[218:219], v17 offset:13184
    s_waitcnt lgkmcnt(8)
    v_mfma_f32_32x32x16_bf16 v[160:175], v[196:199], v[48:51], v[160:175]
    v_mfma_f32_32x32x16_bf16 v[176:191], v[200:203], v[48:51], v[176:191]
    ds_read_b64_tr_b16 v[220:221], v18 offset:12352
    ds_read_b64_tr_b16 v[222:223], v18 offset:13120
    ds_read_b64_tr_b16 v[224:225], v18 offset:12416
    ds_read_b64_tr_b16 v[226:227], v18 offset:13184
    v_mfma_f32_16x16x32_bf16 v[248:251], v[240:243], v[196:199], v[248:251]
    v_mfma_f32_16x16x32_bf16 v[192:195], v[240:243], v[200:203], v[192:195]
    s_waitcnt lgkmcnt(8)
    v_mfma_f32_32x32x16_bf16 v[160:175], v[204:207], v[52:55], v[160:175]
    v_mfma_f32_32x32x16_bf16 v[176:191], v[208:211], v[52:55], v[176:191]
    s_waitcnt vmcnt(6)
    s_barrier
    s_mul_i32 s47, s4, 3
    s_add_u32 s47, s47, 28672
    v_add_u32 v15, s47, v22
    s_mul_i32 s47, s5, 3
    s_add_u32 s47, s47, 28672
    v_add_u32 v16, s47, v22
    s_mul_i32 s47, s6, 3
    s_add_u32 s47, s47, 28672
    v_add_u32 v17, s47, v22
    s_mul_i32 s47, s7, 3
    s_add_u32 s47, s47, 28672
    v_add_u32 v18, s47, v22
    ds_read_b64_tr_b16 v[196:197], v15 offset:64
    ds_read_b64_tr_b16 v[198:199], v15 offset:832
    ds_read_b64_tr_b16 v[200:201], v15 offset:128
    ds_read_b64_tr_b16 v[202:203], v15 offset:896
    s_waitcnt lgkmcnt(8)
    v_mfma_f32_32x32x16_bf16 v[160:175], v[212:215], v[56:59], v[160:175]
    v_mfma_f32_32x32x16_bf16 v[176:191], v[216:219], v[56:59], v[176:191]
    ds_read_b64_tr_b16 v[204:205], v16 offset:64
    ds_read_b64_tr_b16 v[206:207], v16 offset:832
    ds_read_b64_tr_b16 v[208:209], v16 offset:128
    ds_read_b64_tr_b16 v[210:211], v16 offset:896
    s_waitcnt lgkmcnt(8)
    v_mfma_f32_32x32x16_bf16 v[160:175], v[220:223], v[60:63], v[160:175]
    v_mfma_f32_32x32x16_bf16 v[176:191], v[224:227], v[60:63], v[176:191]
    ds_read_b64_tr_b16 v[212:213], v17 offset:64
    ds_read_b64_tr_b16 v[214:215], v17 offset:832
    ds_read_b64_tr_b16 v[216:217], v17 offset:128
    ds_read_b64_tr_b16 v[218:219], v17 offset:896
    s_waitcnt lgkmcnt(8)
    v_mfma_f32_32x32x16_bf16 v[160:175], v[196:199], v[64:67], v[160:175]
    v_mfma_f32_32x32x16_bf16 v[176:191], v[200:203], v[64:67], v[176:191]
    ds_read_b64_tr_b16 v[220:221], v18 offset:64
    ds_read_b64_tr_b16 v[222:223], v18 offset:832
    ds_read_b64_tr_b16 v[224:225], v18 offset:128
    ds_read_b64_tr_b16 v[226:227], v18 offset:896
    s_and_b32 s47, s40, 3
    s_lshl_b32 s47, s47, 1
    s_and_b32 s48, s41, 1
    s_add_u32 s47, s47, s48
    s_lshr_b32 s48, s41, 1
    s_lshl_b32 s48, s48, 7
    v_lshlrev_b32 v2, 10, v0
    v_add_u32 v2, s48, v2
    s_cmp_eq_u32 s43, 3
    s_cbranch_scc1 Lpfo
    s_mul_i32 s47, s47, 172
    s_lshl_b32 s48, s43, 6
    s_add_u32 s47, s47, s48
    s_lshl_b32 s47, s47, 10
    v_add_u32 v2, s47, v2
    buffer_load_dword v1, v2, s[20:23], 0 offen
    buffer_load_dword v4, v2, s[20:23], 0 offen offset:64
    s_branch Lpfe
Lpfo:
    s_lshl_b32 s47, s47, 16
    buffer_load_dword v1, v2, s[24:27], s47 offen
    buffer_load_dword v4, v2, s[24:27], s47 offen offset:64
Lpfe:
    v_mfma_f32_16x16x32_bf16 v[248:251], v[240:243], v[196:199], v[248:251]
    v_mfma_f32_16x16x32_bf16 v[192:195], v[240:243], v[200:203], v[192:195]
    s_waitcnt lgkmcnt(8)
    v_mfma_f32_32x32x16_bf16 v[160:175], v[204:207], v[68:71], v[160:175]
    v_mfma_f32_32x32x16_bf16 v[176:191], v[208:211], v[68:71], v[176:191]
    ds_read_b64_tr_b16 v[196:197], v15 offset:12352
    ds_read_b64_tr_b16 v[198:199], v15 offset:13120
    ds_read_b64_tr_b16 v[200:201], v15 offset:12416
    ds_read_b64_tr_b16 v[202:203], v15 offset:13184
    s_waitcnt lgkmcnt(8)
    v_mfma_f32_32x32x16_bf16 v[160:175], v[212:215], v[72:75], v[160:175]
    v_mfma_f32_32x32x16_bf16 v[176:191], v[216:219], v[72:75], v[176:191]
    ds_read_b64_tr_b16 v[204:205], v16 offset:12352
    ds_read_b64_tr_b16 v[206:207], v16 offset:13120
    ds_read_b64_tr_b16 v[208:209], v16 offset:12416
    ds_read_b64_tr_b16 v[210:211], v16 offset:13184
    s_waitcnt lgkmcnt(8)
    v_mfma_f32_32x32x16_bf16 v[160:175], v[220:223], v[76:79], v[160:175]
    v_mfma_f32_32x32x16_bf16 v[176:191], v[224:227], v[76:79], v[176:191]
    ds_read_b64_tr_b16 v[212:213], v17 offset:12352
    ds_read_b64_tr_b16 v[214:215], v17 offset:13120
    ds_read_b64_tr_b16 v[216:217], v17 offset:12416
    ds_read_b64_tr_b16 v[218:219], v17 offset:13184
    s_waitcnt lgkmcnt(8)
    v_mfma_f32_32x32x16_bf16 v[160:175], v[196:199], v[80:83], v[160:175]
    v_mfma_f32_32x32x16_bf16 v[176:191], v[200:203], v[80:83], v[176:191]
    ds_read_b64_tr_b16 v[220:221], v18 offset:12352
    ds_read_b64_tr_b16 v[222:223], v18 offset:13120
    ds_read_b64_tr_b16 v[224:225], v18 offset:12416
    ds_read_b64_tr_b16 v[226:227], v18 offset:13184
    v_mfma_f32_16x16x32_bf16 v[248:251], v[240:243], v[196:199], v[248:251]
    v_mfma_f32_16x16x32_bf16 v[192:195], v[240:243], v[200:203], v[192:195]
    s_waitcnt lgkmcnt(8)
    v_mfma_f32_32x32x16_bf16 v[160:175], v[204:207], v[84:87], v[160:175]
    v_mfma_f32_32x32x16_bf16 v[176:191], v[208:211], v[84:87], v[176:191]
    s_waitcnt vmcnt(2)
    s_barrier
    s_mul_i32 s47, s4, 3
    s_add_u32 s47, s47, 57344
    v_add_u32 v15, s47, v22
    s_mul_i32 s47, s5, 3
    s_add_u32 s47, s47, 57344
    v_add_u32 v16, s47, v22
    s_mul_i32 s47, s6, 3
    s_add_u32 s47, s47, 57344
    v_add_u32 v17, s47, v22
    s_mul_i32 s47, s7, 3
    s_add_u32 s47, s47, 57344
    v_add_u32 v18, s47, v22
    ds_read_b64_tr_b16 v[196:197], v15 offset:64
    ds_read_b64_tr_b16 v[198:199], v15 offset:832
    ds_read_b64_tr_b16 v[200:201], v15 offset:128
    ds_read_b64_tr_b16 v[202:203], v15 offset:896
    s_waitcnt lgkmcnt(8)
    v_mfma_f32_32x32x16_bf16 v[160:175], v[212:215], v[88:91], v[160:175]
    v_mfma_f32_32x32x16_bf16 v[176:191], v[216:219], v[88:91], v[176:191]
    ds_read_b64_tr_b16 v[204:205], v16 offset:64
    ds_read_b64_tr_b16 v[206:207], v16 offset:832
    ds_read_b64_tr_b16 v[208:209], v16 offset:128
    ds_read_b64_tr_b16 v[210:211], v16 offset:896
    s_waitcnt lgkmcnt(8)
    v_mfma_f32_32x32x16_bf16 v[160:175], v[220:223], v[92:95], v[160:175]
    v_mfma_f32_32x32x16_bf16 v[176:191], v[224:227], v[92:95], v[176:191]
    ds_read_b64_tr_b16 v[212:213], v17 offset:64
    ds_read_b64_tr_b16 v[214:215], v17 offset:832
    ds_read_b64_tr_b16 v[216:217], v17 offset:128
    ds_read_b64_tr_b16 v[218:219], v17 offset:896
    s_waitcnt lgkmcnt(8)
    v_mfma_f32_32x32x16_bf16 v[160:175], v[196:199], v[96:99], v[160:175]
    v_mfma_f32_32x32x16_bf16 v[176:191], v[200:203], v[96:99], v[176:191]
    ds_read_b64_tr_b16 v[220:221], v18 offset:64
    ds_read_b64_tr_b16 v[222:223], v18 offset:832
    ds_read_b64_tr_b16 v[224:225], v18 offset:128
    ds_read_b64_tr_b16 v[226:227], v18 offset:896
    v_mfma_f32_16x16x32_bf16 v[248:251], v[240:243], v[196:199], v[248:251]
    v_mfma_f32_16x16x32_bf16 v[192:195], v[240:243], v[200:203], v[192:195]
    s_waitcnt lgkmcnt(8)
    v_mfma_f32_32x32x16_bf16 v[160:175], v[204:207], v[100:103], v[160:175]
    v_mfma_f32_32x32x16_bf16 v[176:191], v[208:211], v[100:103], v[176:191]
    ds_read_b64_tr_b16 v[196:197], v15 offset:12352
    ds_read_b64_tr_b16 v[198:199], v15 offset:13120
    ds_read_b64_tr_b16 v[200:201], v15 offset:12416
    ds_read_b64_tr_b16 v[202:203], v15 offset:13184
    s_barrier
    s_waitcnt lgkmcnt(8)
    v_mfma_f32_32x32x16_bf16 v[160:175], v[212:215], v[104:107], v[160:175]
    v_mfma_f32_32x32x16_bf16 v[176:191], v[216:219], v[104:107], v[176:191]
    ds_read_b64_tr_b16 v[204:205], v16 offset:12352
    ds_read_b64_tr_b16 v[206:207], v16 offset:13120
    ds_read_b64_tr_b16 v[208:209], v16 offset:12416
    ds_read_b64_tr_b16 v[210:211], v16 offset:13184
    s_waitcnt lgkmcnt(8)
    v_mfma_f32_32x32x16_bf16 v[160:175], v[220:223], v[108:111], v[160:175]
    v_mfma_f32_32x32x16_bf16 v[176:191], v[224:227], v[108:111], v[176:191]
    ds_read_b64_tr_b16 v[212:213], v17 offset:12352
    ds_read_b64_tr_b16 v[214:215], v17 offset:13120
    ds_read_b64_tr_b16 v[216:217], v17 offset:12416
    ds_read_b64_tr_b16 v[218:219], v17 offset:13184
    s_waitcnt lgkmcnt(8)
    v_mfma_f32_32x32x16_bf16 v[160:175], v[196:199], v[112:115], v[160:175]
    v_mfma_f32_32x32x16_bf16 v[176:191], v[200:203], v[112:115], v[176:191]
    ds_read_b64_tr_b16 v[220:221], v18 offset:12352
    ds_read_b64_tr_b16 v[222:223], v18 offset:13120
    ds_read_b64_tr_b16 v[224:225], v18 offset:12416
    ds_read_b64_tr_b16 v[226:227], v18 offset:13184
    v_mfma_f32_16x16x32_bf16 v[248:251], v[240:243], v[196:199], v[248:251]
    v_mfma_f32_16x16x32_bf16 v[192:195], v[240:243], v[200:203], v[192:195]
    s_waitcnt lgkmcnt(8)
    v_mfma_f32_32x32x16_bf16 v[160:175], v[204:207], v[116:119], v[160:175]
    v_mfma_f32_32x32x16_bf16 v[176:191], v[208:211], v[116:119], v[176:191]
    s_mul_i32 s47, s4, 3
    s_add_u32 s47, s47, 86016
    v_add_u32 v15, s47, v22
    s_mul_i32 s47, s5, 3
    s_add_u32 s47, s47, 86016
    v_add_u32 v16, s47, v22
    s_mul_i32 s47, s6, 3
    s_add_u32 s47, s47, 86016
    v_add_u32 v17, s47, v22
    s_mul_i32 s47, s7, 3
    s_add_u32 s47, s47, 86016
    v_add_u32 v18, s47, v22
    ds_read_b64_tr_b16 v[196:197], v15 offset:64
    ds_read_b64_tr_b16 v[198:199], v15 offset:832
    ds_read_b64_tr_b16 v[200:201], v15 offset:128
    ds_read_b64_tr_b16 v[202:203], v15 offset:896
    s_waitcnt lgkmcnt(8)
    v_mfma_f32_32x32x16_bf16 v[160:175], v[212:215], v[120:123], v[160:175]
    v_mfma_f32_32x32x16_bf16 v[176:191], v[216:219], v[120:123], v[176:191]
    ds_read_b64_tr_b16 v[204:205], v16 offset:64
    ds_read_b64_tr_b16 v[206:207], v16 offset:832
    ds_read_b64_tr_b16 v[208:209], v16 offset:128
    ds_read_b64_tr_b16 v[210:211], v16 offset:896
    s_waitcnt lgkmcnt(8)
    v_mfma_f32_32x32x16_bf16 v[160:175], v[220:223], v[124:127], v[160:175]
    v_mfma_f32_32x32x16_bf16 v[176:191], v[224:227], v[124:127], v[176:191]
    ds_read_b64_tr_b16 v[212:213], v17 offset:64
    ds_read_b64_tr_b16 v[214:215], v17 offset:832
    ds_read_b64_tr_b16 v[216:217], v17 offset:128
    ds_read_b64_tr_b16 v[218:219], v17 offset:896
    s_waitcnt lgkmcnt(8)
    v_mfma_f32_32x32x16_bf16 v[160:175], v[196:199], v[128:131], v[160:175]
    v_mfma_f32_32x32x16_bf16 v[176:191], v[200:203], v[128:131], v[176:191]
    ds_read_b64_tr_b16 v[220:221], v18 offset:64
    ds_read_b64_tr_b16 v[222:223], v18 offset:832
    ds_read_b64_tr_b16 v[224:225], v18 offset:128
    ds_read_b64_tr_b16 v[226:227], v18 offset:896
    v_mfma_f32_16x16x32_bf16 v[248:251], v[240:243], v[196:199], v[248:251]
    v_mfma_f32_16x16x32_bf16 v[192:195], v[240:243], v[200:203], v[192:195]
    s_waitcnt lgkmcnt(8)
    v_mfma_f32_32x32x16_bf16 v[160:175], v[204:207], v[132:135], v[160:175]
    v_mfma_f32_32x32x16_bf16 v[176:191], v[208:211], v[132:135], v[176:191]
    ds_read_b64_tr_b16 v[196:197], v15 offset:12352
    ds_read_b64_tr_b16 v[198:199], v15 offset:13120
    ds_read_b64_tr_b16 v[200:201], v15 offset:12416
    ds_read_b64_tr_b16 v[202:203], v15 offset:13184
    s_waitcnt lgkmcnt(8)
    v_mfma_f32_32x32x16_bf16 v[160:175], v[212:215], v[136:139], v[160:175]
    v_mfma_f32_32x32x16_bf16 v[176:191], v[216:219], v[136:139], v[176:191]
    ds_read_b64_tr_b16 v[204:205], v16 offset:12352
    ds_read_b64_tr_b16 v[206:207], v16 offset:13120
    ds_read_b64_tr_b16 v[208:209], v16 offset:12416
    ds_read_b64_tr_b16 v[210:211], v16 offset:13184
    s_waitcnt lgkmcnt(8)
    v_mfma_f32_32x32x16_bf16 v[160:175], v[220:223], v[140:143], v[160:175]
    v_mfma_f32_32x32x16_bf16 v[176:191], v[224:227], v[140:143], v[176:191]
    ds_read_b64_tr_b16 v[212:213], v17 offset:12352
    ds_read_b64_tr_b16 v[214:215], v17 offset:13120
    ds_read_b64_tr_b16 v[216:217], v17 offset:12416
    ds_read_b64_tr_b16 v[218:219], v17 offset:13184
    s_waitcnt lgkmcnt(8)
    v_mfma_f32_32x32x16_bf16 v[160:175], v[196:199], v[144:147], v[160:175]
    v_mfma_f32_32x32x16_bf16 v[176:191], v[200:203], v[144:147], v[176:191]
    ds_read_b64_tr_b16 v[220:221], v18 offset:12352
    ds_read_b64_tr_b16 v[222:223], v18 offset:13120
    ds_read_b64_tr_b16 v[224:225], v18 offset:12416
    ds_read_b64_tr_b16 v[226:227], v18 offset:13184
    v_mfma_f32_16x16x32_bf16 v[248:251], v[240:243], v[196:199], v[248:251]
    v_mfma_f32_16x16x32_bf16 v[192:195], v[240:243], v[200:203], v[192:195]
    s_waitcnt lgkmcnt(8)
    v_mfma_f32_32x32x16_bf16 v[160:175], v[204:207], v[148:151], v[160:175]
    v_mfma_f32_32x32x16_bf16 v[176:191], v[208:211], v[148:151], v[176:191]
    s_waitcnt lgkmcnt(4)
    v_mfma_f32_32x32x16_bf16 v[160:175], v[212:215], v[152:155], v[160:175]
    v_mfma_f32_32x32x16_bf16 v[176:191], v[216:219], v[152:155], v[176:191]
    s_waitcnt lgkmcnt(0)
    v_mfma_f32_32x32x16_bf16 v[160:175], v[220:223], v[156:159], v[160:175]
    v_mfma_f32_32x32x16_bf16 v[176:191], v[224:227], v[156:159], v[176:191]
    v_and_b32 v10, 31, v0
    v_lshlrev_b32 v10, 4, v10
    s_lshl_b32 s47, s43, 2
    v_add_u32 v11, s47, v10
    v_cvt_pk_bf16_f32 v249, v248, v248
    v_lshlrev_b32 v249, 16, v249
    v_sub_f32 v249, v248, v249
    v_cvt_pk_bf16_f32 v250, v248, v249
    ds_write_b32 v11, v250 offset:26624
    v_cvt_pk_bf16_f32 v193, v192, v192
    v_lshlrev_b32 v193, 16, v193
    v_sub_f32 v193, v192, v193
    v_cvt_pk_bf16_f32 v194, v192, v193
    ds_write_b32 v11, v194 offset:27136
    s_and_b32 s49, s42, 1
    s_lshr_b32 s55, s42, 1
    s_mul_i32 s50, s55, 28672
    s_lshl_b32 s47, s49, 10
    s_add_u32 s50, s50, s47
    s_mul_i32 s51, s55, 12288
    s_add_u32 s51, s51, s47
    s_add_u32 s51, s51, 114688
    s_mul_i32 s52, s55, 360448
    s_lshl_b32 s53, s55, 17
    v_lshrrev_b32 v3, 5, v0
    v_bfe_u32 v11, v0, 2, 2
    v_lshl_add_u32 v3, v3, 2, v11
    v_lshlrev_b32 v3, 10, v3
    v_bfe_u32 v11, v0, 4, 1
    v_lshl_add_u32 v3, v11, 6, v3
    v_and_b32 v11, 3, v0
    v_lshl_add_u32 v3, v11, 4, v3
    s_lshr_b32 s47, s41, 1
    s_lshl_b32 s47, s47, 7
    s_lshl_b32 s48, s49, 13
    s_add_u32 s47, s47, s48
    v_add_u32 v3, s47, v3
    s_waitcnt lgkmcnt(0)
    s_barrier
    ds_read_b128 v[224:227], v10 offset:26624
    ds_read_b128 v[228:231], v10 offset:27136
    s_waitcnt lgkmcnt(0)
    v_mfma_f32_32x32x16_bf16 v[160:175], v[224:227], v[244:247], v[160:175]
    v_mfma_f32_32x32x16_bf16 v[176:191], v[228:231], v[244:247], v[176:191]
    s_nop 10
    v_mul_f32 v192, v19, v160
    v_mul_f32 v193, v19, v161
    v_mul_f32 v194, v19, v162
    v_mul_f32 v195, v19, v163
    v_mul_f32 v196, v19, v164
    v_mul_f32 v197, v19, v165
    v_mul_f32 v198, v19, v166
    v_mul_f32 v199, v19, v167
    v_mul_f32 v200, v19, v168
    v_mul_f32 v201, v19, v169
    v_mul_f32 v202, v19, v170
    v_mul_f32 v203, v19, v171
    v_mul_f32 v204, v19, v172
    v_mul_f32 v205, v19, v173
    v_mul_f32 v206, v19, v174
    v_mul_f32 v207, v19, v175
    v_exp_f32 v192, v192
    v_exp_f32 v193, v193
    v_exp_f32 v194, v194
    v_exp_f32 v195, v195
    v_exp_f32 v196, v196
    v_exp_f32 v197, v197
    v_exp_f32 v198, v198
    v_exp_f32 v199, v199
    v_exp_f32 v200, v200
    v_exp_f32 v201, v201
    v_exp_f32 v202, v202
    v_exp_f32 v203, v203
    v_exp_f32 v204, v204
    v_exp_f32 v205, v205
    v_exp_f32 v206, v206
    v_exp_f32 v207, v207
    v_fma_f32 v192, v192, v20, v20
    v_fma_f32 v193, v193, v20, v20
    v_fma_f32 v194, v194, v20, v20
    v_fma_f32 v195, v195, v20, v20
    v_fma_f32 v196, v196, v20, v20
    v_fma_f32 v197, v197, v20, v20
    v_fma_f32 v198, v198, v20, v20
    v_fma_f32 v199, v199, v20, v20
    v_fma_f32 v200, v200, v20, v20
    v_fma_f32 v201, v201, v20, v20
    v_fma_f32 v202, v202, v20, v20
    v_fma_f32 v203, v203, v20, v20
    v_fma_f32 v204, v204, v20, v20
    v_fma_f32 v205, v205, v20, v20
    v_fma_f32 v206, v206, v20, v20
    v_fma_f32 v207, v207, v20, v20
    v_rcp_f32 v192, v192
    v_rcp_f32 v193, v193
    v_rcp_f32 v194, v194
    v_rcp_f32 v195, v195
    v_rcp_f32 v196, v196
    v_rcp_f32 v197, v197
    v_rcp_f32 v198, v198
    v_rcp_f32 v199, v199
    v_rcp_f32 v200, v200
    v_rcp_f32 v201, v201
    v_rcp_f32 v202, v202
    v_rcp_f32 v203, v203
    v_rcp_f32 v204, v204
    v_rcp_f32 v205, v205
    v_rcp_f32 v206, v206
    v_rcp_f32 v207, v207
    v_mul_f32 v160, v160, v192
    v_mul_f32 v161, v161, v193
    v_mul_f32 v162, v162, v194
    v_mul_f32 v163, v163, v195
    v_mul_f32 v164, v164, v196
    v_mul_f32 v165, v165, v197
    v_mul_f32 v166, v166, v198
    v_mul_f32 v167, v167, v199
    v_mul_f32 v168, v168, v200
    v_mul_f32 v169, v169, v201
    v_mul_f32 v170, v170, v202
    v_mul_f32 v171, v171, v203
    v_mul_f32 v172, v172, v204
    v_mul_f32 v173, v173, v205
    v_mul_f32 v174, v174, v206
    v_mul_f32 v175, v175, v207
    v_cvt_pk_bf16_f32 v192, v160, v161
    v_cvt_pk_bf16_f32 v193, v162, v163
    v_cvt_pk_bf16_f32 v194, v164, v165
    v_cvt_pk_bf16_f32 v195, v166, v167
    v_cvt_pk_bf16_f32 v196, v168, v169
    v_cvt_pk_bf16_f32 v197, v170, v171
    v_cvt_pk_bf16_f32 v198, v172, v173
    v_cvt_pk_bf16_f32 v199, v174, v175
    s_mul_i32 s47, s41, 3
    s_add_u32 s47, s47, 1
    s_cmp_lt_u32 s47, 43
    s_cbranch_scc1 nz_10
    v_mov_b32 v192, 0
    v_mov_b32 v193, 0
    v_mov_b32 v194, 0
    v_mov_b32 v195, 0
    v_mov_b32 v196, 0
    v_mov_b32 v197, 0
    v_mov_b32 v198, 0
    v_mov_b32 v199, 0
nz_10:
    s_mul_i32 s48, s59, 48
    s_add_u32 s47, s47, s48
    s_lshl_b32 s47, s47, 11
    s_add_u32 s47, s47, 7340032
    buffer_store_dwordx4 v[192:195], v21, s[32:35], s47 offen sc1
    buffer_store_dwordx4 v[196:199], v21, s[32:35], s47 offen offset:1024 sc1
    v_mul_f32 v208, v19, v176
    v_mul_f32 v209, v19, v177
    v_mul_f32 v210, v19, v178
    v_mul_f32 v211, v19, v179
    v_mul_f32 v212, v19, v180
    v_mul_f32 v213, v19, v181
    v_mul_f32 v214, v19, v182
    v_mul_f32 v215, v19, v183
    v_mul_f32 v216, v19, v184
    v_mul_f32 v217, v19, v185
    v_mul_f32 v218, v19, v186
    v_mul_f32 v219, v19, v187
    v_mul_f32 v220, v19, v188
    v_mul_f32 v221, v19, v189
    v_mul_f32 v222, v19, v190
    v_mul_f32 v223, v19, v191
    v_exp_f32 v208, v208
    v_exp_f32 v209, v209
    v_exp_f32 v210, v210
    v_exp_f32 v211, v211
    v_exp_f32 v212, v212
    v_exp_f32 v213, v213
    v_exp_f32 v214, v214
    v_exp_f32 v215, v215
    v_exp_f32 v216, v216
    v_exp_f32 v217, v217
    v_exp_f32 v218, v218
    v_exp_f32 v219, v219
    v_exp_f32 v220, v220
    v_exp_f32 v221, v221
    v_exp_f32 v222, v222
    v_exp_f32 v223, v223
    v_fma_f32 v208, v208, v20, v20
    v_fma_f32 v209, v209, v20, v20
    v_fma_f32 v210, v210, v20, v20
    v_fma_f32 v211, v211, v20, v20
    v_fma_f32 v212, v212, v20, v20
    v_fma_f32 v213, v213, v20, v20
    v_fma_f32 v214, v214, v20, v20
    v_fma_f32 v215, v215, v20, v20
    v_fma_f32 v216, v216, v20, v20
    v_fma_f32 v217, v217, v20, v20
    v_fma_f32 v218, v218, v20, v20
    v_fma_f32 v219, v219, v20, v20
    v_fma_f32 v220, v220, v20, v20
    v_fma_f32 v221, v221, v20, v20
    v_fma_f32 v222, v222, v20, v20
    v_fma_f32 v223, v223, v20, v20
    v_rcp_f32 v208, v208
    v_rcp_f32 v209, v209
    v_rcp_f32 v210, v210
    v_rcp_f32 v211, v211
    v_rcp_f32 v212, v212
    v_rcp_f32 v213, v213
    v_rcp_f32 v214, v214
    v_rcp_f32 v215, v215
    v_rcp_f32 v216, v216
    v_rcp_f32 v217, v217
    v_rcp_f32 v218, v218
    v_rcp_f32 v219, v219
    v_rcp_f32 v220, v220
    v_rcp_f32 v221, v221
    v_rcp_f32 v222, v222
    v_rcp_f32 v223, v223
    v_mul_f32 v176, v176, v208
    v_mul_f32 v177, v177, v209
    v_mul_f32 v178, v178, v210
    v_mul_f32 v179, v179, v211
    v_mul_f32 v180, v180, v212
    v_mul_f32 v181, v181, v213
    v_mul_f32 v182, v182, v214
    v_mul_f32 v183, v183, v215
    v_mul_f32 v184, v184, v216
    v_mul_f32 v185, v185, v217
    v_mul_f32 v186, v186, v218
    v_mul_f32 v187, v187, v219
    v_mul_f32 v188, v188, v220
    v_mul_f32 v189, v189, v221
    v_mul_f32 v190, v190, v222
    v_mul_f32 v191, v191, v223
    v_cvt_pk_bf16_f32 v208, v176, v177
    v_cvt_pk_bf16_f32 v209, v178, v179
    v_cvt_pk_bf16_f32 v210, v180, v181
    v_cvt_pk_bf16_f32 v211, v182, v183
    v_cvt_pk_bf16_f32 v212, v184, v185
    v_cvt_pk_bf16_f32 v213, v186, v187
    v_cvt_pk_bf16_f32 v214, v188, v189
    v_cvt_pk_bf16_f32 v215, v190, v191
    s_mul_i32 s47, s41, 3
    s_add_u32 s47, s47, 2
    s_cmp_lt_u32 s47, 43
    s_cbranch_scc1 nz_11
    v_mov_b32 v208, 0
    v_mov_b32 v209, 0
    v_mov_b32 v210, 0
    v_mov_b32 v211, 0
    v_mov_b32 v212, 0
    v_mov_b32 v213, 0
    v_mov_b32 v214, 0
    v_mov_b32 v215, 0
nz_11:
    s_mul_i32 s48, s59, 48
    s_add_u32 s47, s47, s48
    s_lshl_b32 s47, s47, 11
    s_add_u32 s47, s47, 7340032
    buffer_store_dwordx4 v[208:211], v21, s[32:35], s47 offen sc1
    buffer_store_dwordx4 v[212:215], v21, s[32:35], s47 offen offset:1024 sc1
Ljoin:
    s_mul_i32 s47, s44, 24576
    s_lshl_b32 s48, s46, 1
    s_add_u32 s47, s47, s48
    s_add_u32 s47, s47, 114688
    v_add_u32 v10, s47, v21
    v_and_b32 v11, 15, v0
    v_lshlrev_b32 v11, 4, v11
    v_lshl_add_u32 v11, v12, 4, v11
    s_add_u32 s47, s47, 1024
    v_add_u32 v11, s47, v11
    v_and_b32 v13, 16, v0
    v_cmp_eq_u32 vcc, 0, v13
    v_mov_b32 v14, 110592
    v_mov_b32 v13, 0x800
    v_cndmask_b32 v11, v14, v11, vcc
    v_cndmask_b32 v13, 0, v13, vcc
    s_sub_u32 s97, 8, s59
    s_and_b32 s47, s41, 1
    s_lshl_b32 s47, s47, 1
    s_add_u32 s47, s47, s49
    s_lshl_b32 s63, s40, 2
    s_add_u32 s63, s63, s47
    s_lshl_b32 s47, s63, 8
    v_lshlrev_b32 v16, 3, v0
    v_and_b32 v16, 0xff, v16
    v_add_u32 v16, s47, v16
    v_add_u32 v17, 32768, v16
    v_add_u32 v16, 16384, v16
    s_mul_i32 s96, s63, 96
    s_mul_i32 s47, s55, 22
    s_add_u32 s96, s96, s47
    s_lshl_b32 s96, s96, 10
    s_add_u32 s96, s96, 7340032
    s_waitcnt lgkmcnt(0)
    s_barrier
    s_cmp_lt_u32 s40, 2
    s_cbranch_scc1 Lslow
    ds_read_b128 v[32:35], v10 offset:0
    ds_read_b128 v[64:67], v10 offset:16384
    ds_read_b128 v[36:39], v10 offset:2048
    ds_read_b128 v[40:43], v10 offset:4096
    ds_read_b128 v[44:47], v10 offset:6144
    ds_read_b128 v[48:51], v10 offset:8192
    ds_read_b128 v[52:55], v10 offset:10240
    ds_read_b128 v[56:59], v10 offset:12288
    ds_read_b128 v[60:63], v10 offset:14336
    s_waitcnt lgkmcnt(7)
    v_mfma_f32_32x32x16_bf16 v[140:155], v[32:35], v[28:31], 0
    v_mfma_f32_32x32x16_bf16 v[188:203], v[64:67], v[28:31], 0
    s_waitcnt lgkmcnt(5)
    v_mfma_f32_32x32x16_bf16 v[156:171], v[36:39], v[28:31], 0
    v_mfma_f32_32x32x16_bf16 v[172:187], v[40:43], v[28:31], 0
    ds_read_b128 v[68:71], v11
    ds_read_b128 v[72:75], v11 offset:512
    v_add_u32 v11, v13, v11
    ds_read_b128 v[76:79], v11
    ds_read_b128 v[80:83], v11 offset:512
    v_add_u32 v11, v13, v11
    s_nop 2
    v_cndmask_b32 v188, v188, v140, s[64:65]
    v_cndmask_b32 v189, v189, v141, s[66:67]
    v_cndmask_b32 v190, v190, v142, s[68:69]
    v_cndmask_b32 v191, v191, v143, s[70:71]
    v_cndmask_b32 v192, v192, v144, s[72:73]
    v_cndmask_b32 v193, v193, v145, s[74:75]
    v_cndmask_b32 v194, v194, v146, s[76:77]
    v_cndmask_b32 v195, v195, v147, s[78:79]
    v_cndmask_b32 v196, v196, v148, s[80:81]
    v_cndmask_b32 v197, v197, v149, s[82:83]
    v_cndmask_b32 v198, v198, v150, s[84:85]
    v_cndmask_b32 v199, v199, v151, s[86:87]
    v_cndmask_b32 v200, v200, v152, s[88:89]
    v_cndmask_b32 v201, v201, v153, s[90:91]
    v_cndmask_b32 v202, v202, v154, s[92:93]
    v_cndmask_b32 v203, v203, v155, s[94:95]
    s_waitcnt lgkmcnt(4)
    v_mfma_f32_32x32x16_bf16 v[140:155], v[44:47], v[28:31], 0
    v_max_f32 v15, v188, v189
    v_max_f32 v18, v190, v191
    v_max3_f32 v15, v192, v193, v15
    v_max3_f32 v18, v194, v195, v18
    v_max3_f32 v15, v196, v197, v15
    v_max3_f32 v18, v198, v199, v18
    v_max3_f32 v15, v200, v201, v15
    v_max3_f32 v18, v202, v203, v18
    ds_read_b128 v[84:87], v11
    ds_read_b128 v[88:91], v11 offset:512
    v_add_u32 v11, v13, v11
    s_cmp_eq_u32 s44, 1
    s_cbranch_scc1 d2_12
    s_add_u32 s48, s52, 770048
    s_add_u32 m0, s50, 63488
    s_nop 0
    buffer_load_dwordx4 v3, s[20:23], s48 offen lds
    s_add_u32 s48, s52, 786432
    s_add_u32 m0, s50, 65536
    s_nop 0
    buffer_load_dwordx4 v3, s[20:23], s48 offen lds
d2_12:
    v_max3_f32 v15, v156, v157, v15
    v_max3_f32 v18, v158, v159, v18
    v_max3_f32 v15, v160, v161, v15
    v_max3_f32 v18, v162, v163, v18
    v_max3_f32 v15, v164, v165, v15
    v_max3_f32 v18, v166, v167, v18
    v_max3_f32 v15, v168, v169, v15
    v_max3_f32 v18, v170, v171, v18
    v_mfma_f32_32x32x16_bf16 v[156:171], v[48:51], v[28:31], 0
    ds_read_b128 v[92:95], v11
    ds_read_b128 v[96:99], v11 offset:512
    v_add_u32 v11, v13, v11
    s_cmp_eq_u32 s44, 1
    s_cbranch_scc1 d2_14
    s_add_u32 s48, s52, 802816
    s_add_u32 m0, s50, 67584
    s_nop 0
    buffer_load_dwordx4 v3, s[20:23], s48 offen lds
    s_add_u32 s48, s52, 819200
    s_add_u32 m0, s50, 69632
    s_nop 0
    buffer_load_dwordx4 v3, s[20:23], s48 offen lds
d2_14:
    v_max3_f32 v15, v172, v173, v15
    v_max3_f32 v18, v174, v175, v18
    v_max3_f32 v15, v176, v177, v15
    v_max3_f32 v18, v178, v179, v18
    v_max3_f32 v15, v180, v181, v15
    v_max3_f32 v18, v182, v183, v18
    v_max3_f32 v15, v184, v185, v15
    v_max3_f32 v18, v186, v187, v18
    v_mfma_f32_32x32x16_bf16 v[172:187], v[52:55], v[28:31], 0
    ds_read_b128 v[100:103], v11
    ds_read_b128 v[104:107], v11 offset:512
    v_add_u32 v11, v13, v11
    s_cmp_eq_u32 s44, 1
    s_cbranch_scc1 d2_16
    s_add_u32 s48, s52, 835584
    s_add_u32 m0, s50, 71680
    s_nop 0
    buffer_load_dwordx4 v3, s[20:23], s48 offen lds
    s_branch d2e_17
d2_16:
    s_waitcnt vmcnt(0)
    s_mov_b64 exec, 1
    s_add_u32 s47, s62, 16384
    buffer_store_dwordx2 v[24:25], v0, s[32:35], s47 offen sc1
    s_mov_b64 exec, -1
d2e_17:
    v_max3_f32 v15, v140, v141, v15
    v_max3_f32 v18, v142, v143, v18
    v_max3_f32 v15, v144, v145, v15
    v_max3_f32 v18, v146, v147, v18
    v_max3_f32 v15, v148, v149, v15
    v_max3_f32 v18, v150, v151, v18
    v_max3_f32 v15, v152, v153, v15
    v_max3_f32 v18, v154, v155, v18
    v_mfma_f32_32x32x16_bf16 v[140:155], v[56:59], v[28:31], 0
    ds_read_b128 v[108:111], v11
    ds_read_b128 v[112:115], v11 offset:512
    v_add_u32 v11, v13, v11
    s_cmp_eq_u32 s44, 1
    s_cbranch_scc1 d2_18
    s_add_u32 s48, s52, 851968
    s_add_u32 m0, s50, 73728
    s_nop 0
    buffer_load_dwordx4 v3, s[20:23], s48 offen lds
d2_18:
    v_max3_f32 v15, v156, v157, v15
    v_max3_f32 v18, v158, v159, v18
    v_max3_f32 v15, v160, v161, v15
    v_max3_f32 v18, v162, v163, v18
    v_max3_f32 v15, v164, v165, v15
    v_max3_f32 v18, v166, v167, v18
    v_max3_f32 v15, v168, v169, v15
    v_max3_f32 v18, v170, v171, v18
    v_mfma_f32_32x32x16_bf16 v[156:171], v[60:63], v[28:31], 0
    ds_read_b128 v[116:119], v11
    ds_read_b128 v[120:123], v11 offset:512
    v_add_u32 v11, v13, v11
    s_cmp_eq_u32 s44, 1
    s_cbranch_scc1 d2_20
    s_add_u32 s48, s52, 868352
    s_add_u32 m0, s50, 75776
    s_nop 0
    buffer_load_dwordx4 v3, s[20:23], s48 offen lds
d2_20:
    v_max3_f32 v15, v172, v173, v15
    v_max3_f32 v18, v174, v175, v18
    v_max3_f32 v15, v176, v177, v15
    v_max3_f32 v18, v178, v179, v18
    v_max3_f32 v15, v180, v181, v15
    v_max3_f32 v18, v182, v183, v18
    v_max3_f32 v15, v184, v185, v15
    v_max3_f32 v18, v186, v187, v18
    s_waitcnt lgkmcnt(8)
    ds_read_b128 v[124:127], v11
    ds_read_b128 v[128:131], v11 offset:512
    v_add_u32 v11, v13, v11
    s_cmp_eq_u32 s44, 1
    s_cbranch_scc1 d2_22
    s_add_u32 s48, s52, 884736
    s_add_u32 m0, s50, 77824
    s_nop 0
    buffer_load_dwordx4 v3, s[20:23], s48 offen lds
d2_22:
    v_max3_f32 v15, v140, v141, v15
    v_max3_f32 v18, v142, v143, v18
    v_max3_f32 v15, v144, v145, v15
    v_max3_f32 v18, v146, v147, v18
    v_max3_f32 v15, v148, v149, v15
    v_max3_f32 v18, v150, v151, v18
    v_max3_f32 v15, v152, v153, v15
    v_max3_f32 v18, v154, v155, v18
    s_waitcnt lgkmcnt(8)
    ds_read_b128 v[132:135], v11
    ds_read_b128 v[136:139], v11 offset:512
    s_cmp_eq_u32 s44, 1
    s_cbranch_scc1 d2_24
    s_add_u32 s48, s52, 901120
    s_add_u32 m0, s50, 79872
    s_nop 0
    buffer_load_dwordx4 v3, s[20:23], s48 offen lds
d2_24:
    v_max3_f32 v15, v156, v157, v15
    v_max3_f32 v18, v158, v159, v18
    v_max3_f32 v15, v160, v161, v15
    v_max3_f32 v18, v162, v163, v18
    v_max3_f32 v15, v164, v165, v15
    v_max3_f32 v18, v166, v167, v18
    v_max3_f32 v15, v168, v169, v15
    v_max3_f32 v18, v170, v171, v18
    v_max_f32 v15, v15, v18
    v_mov_b32 v18, v15
    s_nop 1
    v_permlane32_swap_b32 v15, v18
    v_max_f32 v15, v15, v18
    v_sub_f32 v204, 0, v15
    v_sub_f32 v205, 0, v15
    v_sub_f32 v206, 0, v15
    v_sub_f32 v207, 0, v15
    v_sub_f32 v208, 0, v15
    v_sub_f32 v209, 0, v15
    v_sub_f32 v210, 0, v15
    v_sub_f32 v211, 0, v15
    v_sub_f32 v212, 0, v15
    v_sub_f32 v213, 0, v15
    v_sub_f32 v214, 0, v15
    v_sub_f32 v215, 0, v15
    v_sub_f32 v216, 0, v15
    v_sub_f32 v217, 0, v15
    v_sub_f32 v218, 0, v15
    v_sub_f32 v219, 0, v15
    s_nop 1
    v_mfma_f32_32x32x16_bf16 v[156:171], v[36:39], v[28:31], v[204:219]
    v_mfma_f32_32x32x16_bf16 v[172:187], v[40:43], v[28:31], v[204:219]
    s_waitcnt lgkmcnt(0)
    s_barrier
    s_cmp_eq_u32 s44, 0
    s_cbranch_scc1 Lpr
    s_setprio 2
Lpr:
    v_sub_f32 v188, v188, v15
    v_sub_f32 v189, v189, v15
    v_sub_f32 v190, v190, v15
    v_sub_f32 v191, v191, v15
    v_sub_f32 v192, v192, v15
    v_sub_f32 v193, v193, v15
    v_sub_f32 v194, v194, v15
    v_sub_f32 v195, v195, v15
    v_sub_f32 v196, v196, v15
    v_sub_f32 v197, v197, v15
    v_sub_f32 v198, v198, v15
    v_sub_f32 v199, v199, v15
    v_sub_f32 v200, v200, v15
    v_sub_f32 v201, v201, v15
    v_sub_f32 v202, v202, v15
    v_sub_f32 v203, v203, v15
    s_cmp_eq_u32 s44, 1
    s_cbranch_scc1 d2_26
    s_add_u32 s48, s52, 196608
    s_add_u32 m0, s51, 0
    s_nop 0
    buffer_load_dwordx4 v3, s[20:23], s48 offen lds
    s_add_u32 s48, s52, 917504
    s_add_u32 m0, s51, 24576
    s_nop 0
    buffer_load_dwordx4 v3, s[20:23], s48 offen lds
    s_add_u32 s48, s52, 212992
    s_add_u32 m0, s51, 2048
    s_nop 0
    buffer_load_dwordx4 v3, s[20:23], s48 offen lds
    s_add_u32 s48, s52, 933888
    s_add_u32 m0, s51, 26624
    s_nop 0
    buffer_load_dwordx4 v3, s[20:23], s48 offen lds
d2_26:
    v_exp_f32 v188, v188
    v_exp_f32 v189, v189
    v_exp_f32 v190, v190
    v_exp_f32 v191, v191
    v_exp_f32 v192, v192
    v_exp_f32 v193, v193
    v_exp_f32 v194, v194
    v_exp_f32 v195, v195
    v_exp_f32 v196, v196
    v_exp_f32 v197, v197
    v_exp_f32 v198, v198
    v_exp_f32 v199, v199
    v_exp_f32 v200, v200
    v_exp_f32 v201, v201
    v_exp_f32 v202, v202
    v_exp_f32 v203, v203
    v_cvt_pk_bf16_f32 v220, v188, v189
    v_cvt_pk_bf16_f32 v221, v190, v191
    v_cvt_pk_bf16_f32 v222, v192, v193
    v_cvt_pk_bf16_f32 v223, v194, v195
    v_cvt_pk_bf16_f32 v224, v196, v197
    v_cvt_pk_bf16_f32 v225, v198, v199
    v_cvt_pk_bf16_f32 v226, v200, v201
    v_cvt_pk_bf16_f32 v227, v202, v203
    v_and_b32 v240, v232, v220
    v_and_b32 v241, v233, v221
    v_and_b32 v242, v234, v222
    v_and_b32 v243, v235, v223
    v_and_b32 v244, v236, v224
    v_and_b32 v245, v237, v225
    v_and_b32 v246, v238, v226
    v_and_b32 v247, v239, v227
    v_xor_b32 v220, v220, v240
    v_xor_b32 v221, v221, v241
    v_xor_b32 v222, v222, v242
    v_xor_b32 v223, v223, v243
    v_xor_b32 v224, v224, v244
    v_xor_b32 v225, v225, v245
    v_xor_b32 v226, v226, v246
    v_xor_b32 v227, v227, v247
    v_mfma_f32_32x32x16_bf16 v[188:203], v[132:135], v[220:223], 0
    s_nop 0
    v_mfma_f32_32x32x16_bf16 v[188:203], v[136:139], v[224:227], v[188:203]
    v_mfma_f32_32x32x16_bf16 v[188:203], v[68:71], v[240:243], v[188:203]
    v_mfma_f32_32x32x16_bf16 v[188:203], v[72:75], v[244:247], v[188:203]
    v_mfma_f32_32x32x16_bf16 v[140:155], v[44:47], v[28:31], v[204:219]
    s_cmp_eq_u32 s44, 1
    s_cbranch_scc1 d2_28
    s_add_u32 s48, s52, 229376
    s_add_u32 m0, s51, 4096
    s_nop 0
    buffer_load_dwordx4 v3, s[20:23], s48 offen lds
    s_add_u32 s48, s52, 950272
    s_add_u32 m0, s51, 28672
    s_nop 0
    buffer_load_dwordx4 v3, s[20:23], s48 offen lds
    s_add_u32 s48, s52, 245760
    s_add_u32 m0, s51, 6144
    s_nop 0
    buffer_load_dwordx4 v3, s[20:23], s48 offen lds
    s_add_u32 s48, s52, 966656
    s_add_u32 m0, s51, 30720
    s_nop 0
    buffer_load_dwordx4 v3, s[20:23], s48 offen lds
d2_28:
    v_exp_f32 v156, v156
    v_exp_f32 v157, v157
    v_exp_f32 v158, v158
    v_exp_f32 v159, v159
    v_exp_f32 v160, v160
    v_exp_f32 v161, v161
    v_exp_f32 v162, v162
    v_exp_f32 v163, v163
    v_exp_f32 v164, v164
    v_exp_f32 v165, v165
    v_exp_f32 v166, v166
    v_exp_f32 v167, v167
    v_exp_f32 v168, v168
    v_exp_f32 v169, v169
    v_exp_f32 v170, v170
    v_exp_f32 v171, v171
    v_cvt_pk_bf16_f32 v220, v156, v157
    v_cvt_pk_bf16_f32 v221, v158, v159
    v_cvt_pk_bf16_f32 v222, v160, v161
    v_cvt_pk_bf16_f32 v223, v162, v163
    v_cvt_pk_bf16_f32 v224, v164, v165
    v_cvt_pk_bf16_f32 v225, v166, v167
    v_cvt_pk_bf16_f32 v226, v168, v169
    v_cvt_pk_bf16_f32 v227, v170, v171
    v_mfma_f32_32x32x16_bf16 v[188:203], v[76:79], v[220:223], v[188:203]
    s_nop 0
    v_mfma_f32_32x32x16_bf16 v[188:203], v[80:83], v[224:227], v[188:203]
    v_mfma_f32_32x32x16_bf16 v[156:171], v[48:51], v[28:31], v[204:219]
    s_cmp_eq_u32 s44, 1
    s_cbranch_scc1 d2_30
    s_add_u32 s48, s52, 262144
    s_add_u32 m0, s51, 8192
    s_nop 0
    buffer_load_dwordx4 v3, s[20:23], s48 offen lds
    s_add_u32 s48, s52, 983040
    s_add_u32 m0, s51, 32768
    s_nop 0
    buffer_load_dwordx4 v3, s[20:23], s48 offen lds
    s_add_u32 s48, s52, 278528
    s_add_u32 m0, s51, 10240
    s_nop 0
    buffer_load_dwordx4 v3, s[20:23], s48 offen lds
    s_add_u32 s48, s52, 999424
    s_add_u32 m0, s51, 34816
    s_nop 0
    buffer_load_dwordx4 v3, s[20:23], s48 offen lds
d2_30:
    v_exp_f32 v172, v172
    v_exp_f32 v173, v173
    v_exp_f32 v174, v174
    v_exp_f32 v175, v175
    v_exp_f32 v176, v176
    v_exp_f32 v177, v177
    v_exp_f32 v178, v178
    v_exp_f32 v179, v179
    v_exp_f32 v180, v180
    v_exp_f32 v181, v181
    v_exp_f32 v182, v182
    v_exp_f32 v183, v183
    v_exp_f32 v184, v184
    v_exp_f32 v185, v185
    v_exp_f32 v186, v186
    v_exp_f32 v187, v187
    v_cvt_pk_bf16_f32 v240, v172, v173
    v_cvt_pk_bf16_f32 v241, v174, v175
    v_cvt_pk_bf16_f32 v242, v176, v177
    v_cvt_pk_bf16_f32 v243, v178, v179
    v_cvt_pk_bf16_f32 v244, v180, v181
    v_cvt_pk_bf16_f32 v245, v182, v183
    v_cvt_pk_bf16_f32 v246, v184, v185
    v_cvt_pk_bf16_f32 v247, v186, v187
    v_mfma_f32_32x32x16_bf16 v[188:203], v[84:87], v[240:243], v[188:203]
    s_nop 0
    v_mfma_f32_32x32x16_bf16 v[188:203], v[88:91], v[244:247], v[188:203]
    v_mfma_f32_32x32x16_bf16 v[172:187], v[52:55], v[28:31], v[204:219]
    buffer_load_dwordx2 v[228:229], v16, s[32:35], 0 offen sc1
    s_cmp_eq_u32 s44, 1
    s_cbranch_scc1 d2_32
    s_add_u32 s48, s52, 294912
    s_add_u32 m0, s50, 24576
    s_nop 0
    buffer_load_dwordx4 v3, s[20:23], s48 offen lds
    s_add_u32 s48, s52, 1015808
    s_add_u32 m0, s50, 81920
    s_nop 0
    buffer_load_dwordx4 v3, s[20:23], s48 offen lds
d2_32:
    v_exp_f32 v140, v140
    v_exp_f32 v141, v141
    v_exp_f32 v142, v142
    v_exp_f32 v143, v143
    v_exp_f32 v144, v144
    v_exp_f32 v145, v145
    v_exp_f32 v146, v146
    v_exp_f32 v147, v147
    v_exp_f32 v148, v148
    v_exp_f32 v149, v149
    v_exp_f32 v150, v150
    v_exp_f32 v151, v151
    v_exp_f32 v152, v152
    v_exp_f32 v153, v153
    v_exp_f32 v154, v154
    v_exp_f32 v155, v155
    v_cvt_pk_bf16_f32 v220, v140, v141
    v_cvt_pk_bf16_f32 v221, v142, v143
    v_cvt_pk_bf16_f32 v222, v144, v145
    v_cvt_pk_bf16_f32 v223, v146, v147
    v_cvt_pk_bf16_f32 v224, v148, v149
    v_cvt_pk_bf16_f32 v225, v150, v151
    v_cvt_pk_bf16_f32 v226, v152, v153
    v_cvt_pk_bf16_f32 v227, v154, v155
    v_mfma_f32_32x32x16_bf16 v[188:203], v[92:95], v[220:223], v[188:203]
    s_nop 0
    v_mfma_f32_32x32x16_bf16 v[188:203], v[96:99], v[224:227], v[188:203]
    v_mfma_f32_32x32x16_bf16 v[140:155], v[56:59], v[28:31], v[204:219]
    s_setprio 0
    s_cmp_eq_u32 s44, 1
    s_cbranch_scc1 d2_34
    s_add_u32 s48, s52, 311296
    s_add_u32 m0, s50, 26624
    s_nop 0
    buffer_load_dwordx4 v3, s[20:23], s48 offen lds
    s_add_u32 s48, s52, 1032192
    s_add_u32 m0, s50, 83968
    s_nop 0
    buffer_load_dwordx4 v3, s[20:23], s48 offen lds
d2_34:
    v_exp_f32 v156, v156
    v_exp_f32 v157, v157
    v_exp_f32 v158, v158
    v_exp_f32 v159, v159
    v_exp_f32 v160, v160
    v_exp_f32 v161, v161
    v_exp_f32 v162, v162
    v_exp_f32 v163, v163
    v_exp_f32 v164, v164
    v_exp_f32 v165, v165
    v_exp_f32 v166, v166
    v_exp_f32 v167, v167
    v_exp_f32 v168, v168
    v_exp_f32 v169, v169
    v_exp_f32 v170, v170
    v_exp_f32 v171, v171
    v_cvt_pk_bf16_f32 v240, v156, v157
    v_cvt_pk_bf16_f32 v241, v158, v159
    v_cvt_pk_bf16_f32 v242, v160, v161
    v_cvt_pk_bf16_f32 v243, v162, v163
    v_cvt_pk_bf16_f32 v244, v164, v165
    v_cvt_pk_bf16_f32 v245, v166, v167
    v_cvt_pk_bf16_f32 v246, v168, v169
    v_cvt_pk_bf16_f32 v247, v170, v171
    v_mfma_f32_32x32x16_bf16 v[188:203], v[100:103], v[240:243], v[188:203]
    s_nop 0
    v_mfma_f32_32x32x16_bf16 v[188:203], v[104:107], v[244:247], v[188:203]
    v_mfma_f32_32x32x16_bf16 v[156:171], v[60:63], v[28:31], v[204:219]
    s_waitcnt vmcnt(4)
    s_cmp_eq_u32 s44, 0
    s_cbranch_scc1 w_36
    s_waitcnt vmcnt(0)
w_36:
    v_cmp_ne_u64 vcc, s[56:57], v[228:229]
    s_nop 1
    s_mov_b32 s101, vcc_lo
    v_exp_f32 v172, v172
    s_cmp_lg_u32 s101, 0
    s_cbranch_scc1 e_37
    buffer_load_dwordx4 v[32:35], v21, s[32:35], s96 offen offset:0 sc1
e_37:
    v_exp_f32 v173, v173
    v_exp_f32 v174, v174
    v_exp_f32 v175, v175
    v_exp_f32 v176, v176
    v_exp_f32 v177, v177
    v_exp_f32 v178, v178
    v_exp_f32 v179, v179
    v_exp_f32 v180, v180
    s_cmp_lg_u32 s101, 0
    s_cbranch_scc1 e_38
    buffer_load_dwordx4 v[64:67], v21, s[32:35], s96 offen offset:1024 sc1
e_38:
    v_exp_f32 v181, v181
    v_exp_f32 v182, v182
    v_exp_f32 v183, v183
    v_exp_f32 v184, v184
    v_exp_f32 v185, v185
    v_exp_f32 v186, v186
    v_exp_f32 v187, v187
    s_cmp_lg_u32 s101, 0
    s_cbranch_scc1 e_39
    buffer_load_dwordx4 v[36:39], v21, s[32:35], s96 offen offset:2048 sc1
e_39:
    v_cvt_pk_bf16_f32 v220, v172, v173
    v_cvt_pk_bf16_f32 v221, v174, v175
    v_cvt_pk_bf16_f32 v222, v176, v177
    v_cvt_pk_bf16_f32 v223, v178, v179
    v_cvt_pk_bf16_f32 v224, v180, v181
    v_cvt_pk_bf16_f32 v225, v182, v183
    v_cvt_pk_bf16_f32 v226, v184, v185
    v_cvt_pk_bf16_f32 v227, v186, v187
    v_mfma_f32_32x32x16_bf16 v[188:203], v[108:111], v[220:223], v[188:203]
    s_nop 0
    v_mfma_f32_32x32x16_bf16 v[188:203], v[112:115], v[224:227], v[188:203]
    v_exp_f32 v140, v140
    s_cmp_lg_u32 s101, 0
    s_cbranch_scc1 e_40
    buffer_load_dwordx4 v[40:43], v21, s[32:35], s96 offen offset:3072 sc1
e_40:
    v_exp_f32 v141, v141
    v_exp_f32 v142, v142
    v_exp_f32 v143, v143
    v_exp_f32 v144, v144
    v_exp_f32 v145, v145
    v_exp_f32 v146, v146
    v_exp_f32 v147, v147
    v_exp_f32 v148, v148
    s_cmp_lg_u32 s101, 0
    s_cbranch_scc1 e_41
    s_add_u32 s96, s96, 4096
    buffer_load_dwordx4 v[132:135], v21, s[32:35], s96 offen offset:0 sc1
e_41:
    v_exp_f32 v149, v149
    v_exp_f32 v150, v150
    v_exp_f32 v151, v151
    v_exp_f32 v152, v152
    v_exp_f32 v153, v153
    v_exp_f32 v154, v154
    v_exp_f32 v155, v155
    s_cmp_lg_u32 s101, 0
    s_cbranch_scc1 e_42
    buffer_load_dwordx4 v[136:139], v21, s[32:35], s96 offen offset:1024 sc1
e_42:
    v_cvt_pk_bf16_f32 v240, v140, v141
    v_cvt_pk_bf16_f32 v241, v142, v143
    v_cvt_pk_bf16_f32 v242, v144, v145
    v_cvt_pk_bf16_f32 v243, v146, v147
    v_cvt_pk_bf16_f32 v244, v148, v149
    v_cvt_pk_bf16_f32 v245, v150, v151
    v_cvt_pk_bf16_f32 v246, v152, v153
    v_cvt_pk_bf16_f32 v247, v154, v155
    v_mfma_f32_32x32x16_bf16 v[188:203], v[116:119], v[240:243], v[188:203]
    s_nop 0
    v_mfma_f32_32x32x16_bf16 v[188:203], v[120:123], v[244:247], v[188:203]
    buffer_load_dwordx2 v[228:229], v16, s[32:35], 0 offen sc1
    v_exp_f32 v156, v156
    s_cmp_lg_u32 s101, 0
    s_cbranch_scc1 e_43
    buffer_load_dwordx4 v[68:71], v21, s[32:35], s96 offen offset:2048 sc1
e_43:
    v_exp_f32 v157, v157
    v_exp_f32 v158, v158
    v_exp_f32 v159, v159
    v_exp_f32 v160, v160
    v_exp_f32 v161, v161
    v_exp_f32 v162, v162
    v_exp_f32 v163, v163
    v_exp_f32 v164, v164
    s_cmp_lg_u32 s101, 0
    s_cbranch_scc1 e_44
    buffer_load_dwordx4 v[72:75], v21, s[32:35], s96 offen offset:3072 sc1
e_44:
    v_exp_f32 v165, v165
    v_exp_f32 v166, v166
    v_exp_f32 v167, v167
    v_exp_f32 v168, v168
    v_exp_f32 v169, v169
    v_exp_f32 v170, v170
    v_exp_f32 v171, v171
    s_cmp_lg_u32 s101, 0
    s_cbranch_scc1 e_45
    s_add_u32 s96, s96, 4096
    buffer_load_dwordx4 v[44:47], v21, s[32:35], s96 offen offset:0 sc1
e_45:
    v_cvt_pk_bf16_f32 v220, v156, v157
    v_cvt_pk_bf16_f32 v221, v158, v159
    v_cvt_pk_bf16_f32 v222, v160, v161
    v_cvt_pk_bf16_f32 v223, v162, v163
    v_cvt_pk_bf16_f32 v224, v164, v165
    v_cvt_pk_bf16_f32 v225, v166, v167
    v_cvt_pk_bf16_f32 v226, v168, v169
    v_cvt_pk_bf16_f32 v227, v170, v171
    v_mfma_f32_32x32x16_bf16 v[188:203], v[124:127], v[220:223], v[188:203]
    s_nop 0
    v_mfma_f32_32x32x16_bf16 v[188:203], v[128:131], v[224:227], v[188:203]
Lattd:
    s_lshl_b32 s47, s59, 5
    s_lshl_b32 s48, s41, 1
    s_add_u32 s47, s47, s48
    s_add_u32 s47, s47, s44
    s_lshl_b32 s47, s47, 10
    s_add_u32 s47, s47, 5242880
    s_nop 5
    v_rcp_f32 v13, v196
    s_nop 0
    v_mul_f32 v188, v188, v13
    v_mul_f32 v189, v189, v13
    v_mul_f32 v190, v190, v13
    v_mul_f32 v191, v191, v13
    v_mul_f32 v192, v192, v13
    v_mul_f32 v193, v193, v13
    v_mul_f32 v194, v194, v13
    v_mul_f32 v195, v195, v13
    v_cvt_pk_bf16_f32 v220, v188, v189
    v_cvt_pk_bf16_f32 v221, v190, v191
    v_cvt_pk_bf16_f32 v222, v192, v193
    v_cvt_pk_bf16_f32 v223, v194, v195
    buffer_store_dwordx4 v[220:223], v21, s[32:35], s47 offen sc1
    s_cmp_eq_u32 s101, 0
    s_cbranch_scc1 Learly
    s_waitcnt vmcnt(1)
    s_mov_b32 s47, 0x40000
poll_46:
    v_cmp_ne_u64 vcc, s[56:57], v[228:229]
    s_nop 1
    s_and_b32 vcc_lo, vcc_lo, 0xffffffff
    s_cbranch_scc0 pdone_47
    s_sub_u32 s47, s47, 1
    s_cbranch_scc1 pdone_47
    s_sleep 1
    buffer_load_dwordx2 v[228:229], v16, s[32:35], 0 offen sc1
    s_waitcnt vmcnt(0)
    s_branch poll_46
pdone_47:
    buffer_load_dwordx4 v[32:35], v21, s[32:35], s96 offen offset:0 sc1
    buffer_load_dwordx4 v[64:67], v21, s[32:35], s96 offen offset:1024 sc1
    buffer_load_dwordx4 v[36:39], v21, s[32:35], s96 offen offset:2048 sc1
    buffer_load_dwordx4 v[40:43], v21, s[32:35], s96 offen offset:3072 sc1
    s_add_u32 s96, s96, 4096
    buffer_load_dwordx4 v[132:135], v21, s[32:35], s96 offen offset:0 sc1
    buffer_load_dwordx4 v[136:139], v21, s[32:35], s96 offen offset:1024 sc1
    buffer_load_dwordx4 v[68:71], v21, s[32:35], s96 offen offset:2048 sc1
    buffer_load_dwordx4 v[72:75], v21, s[32:35], s96 offen offset:3072 sc1
    s_add_u32 s96, s96, 4096
    buffer_load_dwordx4 v[44:47], v21, s[32:35], s96 offen offset:0 sc1
Learly:
    v_and_b32 v10, 31, v0
    v_lshlrev_b32 v10, 10, v10
    v_add_u32 v10, v10, v12
    s_lshl_b32 s47, s63, 15
    s_lshr_b32 s48, s41, 1
    s_lshl_b32 s48, s48, 7
    s_add_u32 s47, s47, s48
    s_lshl_b32 s48, s55, 5
    s_add_u32 s47, s47, s48
    v_add_u32 v10, s47, v10
    s_lshl_b32 s47, s49, 10
    s_sub_u32 s48, s50, s47
    v_add_u32 v13, s48, v9
    s_sub_u32 s48, s51, s47
    v_add_u32 v14, s48, v9
    buffer_load_dwordx4 v[216:219], v10, s[8:11], 0 offen
    s_barrier
    ds_read_b64_tr_b16 v[192:193], v13 offset:0
    ds_read_b64_tr_b16 v[194:195], v13 offset:1024
    ds_read_b64_tr_b16 v[196:197], v13 offset:256
    ds_read_b64_tr_b16 v[198:199], v13 offset:1280
    ds_read_b64_tr_b16 v[200:201], v13 offset:2048
    ds_read_b64_tr_b16 v[202:203], v13 offset:3072
    ds_read_b64_tr_b16 v[204:205], v13 offset:2304
    ds_read_b64_tr_b16 v[206:207], v13 offset:3328
    ds_read_b64_tr_b16 v[208:209], v13 offset:4096
    ds_read_b64_tr_b16 v[210:211], v13 offset:5120
    ds_read_b64_tr_b16 v[212:213], v13 offset:4352
    ds_read_b64_tr_b16 v[214:215], v13 offset:5376
    s_waitcnt vmcnt(9)
    s_waitcnt lgkmcnt(8)
    v_mfma_f32_32x32x16_bf16 v[144:159], v[192:195], v[32:35], 0
    v_mfma_f32_32x32x16_bf16 v[160:175], v[196:199], v[32:35], 0
    buffer_load_dwordx4 v[76:79], v21, s[32:35], s96 offen offset:1024 sc1
    ds_read_b64_tr_b16 v[192:193], v13 offset:6144
    ds_read_b64_tr_b16 v[194:195], v13 offset:7168
    ds_read_b64_tr_b16 v[196:197], v13 offset:6400
    ds_read_b64_tr_b16 v[198:199], v13 offset:7424
    s_waitcnt vmcnt(9)
    s_waitcnt lgkmcnt(8)
    v_mfma_f32_32x32x16_bf16 v[144:159], v[200:203], v[64:67], v[144:159]
    v_mfma_f32_32x32x16_bf16 v[160:175], v[204:207], v[64:67], v[160:175]
    buffer_load_dwordx4 v[80:83], v21, s[32:35], s96 offen offset:2048 sc1
    ds_read_b64_tr_b16 v[200:201], v13 offset:8192
    ds_read_b64_tr_b16 v[202:203], v13 offset:9216
    ds_read_b64_tr_b16 v[204:205], v13 offset:8448
    ds_read_b64_tr_b16 v[206:207], v13 offset:9472
    s_waitcnt vmcnt(9)
    s_waitcnt vmcnt(3)
    s_mov_b64 exec, 1
    s_add_u32 s47, s62, 32768
    buffer_store_dwordx2 v[24:25], v0, s[32:35], s47 offen sc1
    s_mov_b64 exec, -1
    s_waitcnt lgkmcnt(8)
    v_mfma_f32_32x32x16_bf16 v[144:159], v[208:211], v[36:39], v[144:159]
    v_mfma_f32_32x32x16_bf16 v[160:175], v[212:215], v[36:39], v[160:175]
    buffer_load_dwordx4 v[48:51], v21, s[32:35], s96 offen offset:3072 sc1
    ds_read_b64_tr_b16 v[208:209], v13 offset:10240
    ds_read_b64_tr_b16 v[210:211], v13 offset:11264
    ds_read_b64_tr_b16 v[212:213], v13 offset:10496
    ds_read_b64_tr_b16 v[214:215], v13 offset:11520
    s_waitcnt lgkmcnt(8)
    v_mfma_f32_32x32x16_bf16 v[144:159], v[192:195], v[40:43], v[144:159]
    v_mfma_f32_32x32x16_bf16 v[160:175], v[196:199], v[40:43], v[160:175]
    s_add_u32 s96, s96, 4096
    buffer_load_dwordx4 v[84:87], v21, s[32:35], s96 offen offset:0 sc1
    ds_read_b64_tr_b16 v[192:193], v13 offset:12288
    ds_read_b64_tr_b16 v[194:195], v13 offset:13312
    ds_read_b64_tr_b16 v[196:197], v13 offset:12544
    ds_read_b64_tr_b16 v[198:199], v13 offset:13568
    s_waitcnt lgkmcnt(8)
    v_mfma_f32_32x32x16_bf16 v[144:159], v[200:203], v[132:135], v[144:159]
    v_mfma_f32_32x32x16_bf16 v[160:175], v[204:207], v[132:135], v[160:175]
    buffer_load_dwordx4 v[88:91], v21, s[32:35], s96 offen offset:1024 sc1
    ds_read_b64_tr_b16 v[200:201], v13 offset:14336
    ds_read_b64_tr_b16 v[202:203], v13 offset:15360
    ds_read_b64_tr_b16 v[204:205], v13 offset:14592
    ds_read_b64_tr_b16 v[206:207], v13 offset:15616
    s_waitcnt lgkmcnt(8)
    v_mfma_f32_32x32x16_bf16 v[144:159], v[208:211], v[136:139], v[144:159]
    v_mfma_f32_32x32x16_bf16 v[160:175], v[212:215], v[136:139], v[160:175]
    buffer_load_dwordx4 v[52:55], v21, s[32:35], s96 offen offset:2048 sc1
    s_barrier
    s_add_u32 s48, s52, 327680
    s_add_u32 m0, s50, 0
    s_nop 0
    buffer_load_dwordx4 v3, s[20:23], s48 offen lds
    ds_read_b64_tr_b16 v[208:209], v13 offset:16384
    ds_read_b64_tr_b16 v[210:211], v13 offset:17408
    ds_read_b64_tr_b16 v[212:213], v13 offset:16640
    ds_read_b64_tr_b16 v[214:215], v13 offset:17664
    s_waitcnt lgkmcnt(8)
    v_mfma_f32_32x32x16_bf16 v[144:159], v[192:195], v[68:71], v[144:159]
    v_mfma_f32_32x32x16_bf16 v[160:175], v[196:199], v[68:71], v[160:175]
    buffer_load_dwordx4 v[92:95], v21, s[32:35], s96 offen offset:3072 sc1
    s_add_u32 s48, s52, 344064
    s_add_u32 m0, s50, 2048
    s_nop 0
    buffer_load_dwordx4 v3, s[20:23], s48 offen lds
    ds_read_b64_tr_b16 v[192:193], v13 offset:18432
    ds_read_b64_tr_b16 v[194:195], v13 offset:19456
    ds_read_b64_tr_b16 v[196:197], v13 offset:18688
    ds_read_b64_tr_b16 v[198:199], v13 offset:19712
    s_waitcnt lgkmcnt(8)
    v_mfma_f32_32x32x16_bf16 v[144:159], v[200:203], v[72:75], v[144:159]
    v_mfma_f32_32x32x16_bf16 v[160:175], v[204:207], v[72:75], v[160:175]
    s_add_u32 s96, s96, 4096
    buffer_load_dwordx4 v[96:99], v21, s[32:35], s96 offen offset:0 sc1
    s_add_u32 s48, s53, 0
    s_add_u32 m0, s50, 4096
    s_nop 0
    buffer_load_dwordx4 v3, s[24:27], s48 offen lds
    ds_read_b64_tr_b16 v[200:201], v13 offset:20480
    ds_read_b64_tr_b16 v[202:203], v13 offset:21504
    ds_read_b64_tr_b16 v[204:205], v13 offset:20736
    ds_read_b64_tr_b16 v[206:207], v13 offset:21760
    s_waitcnt lgkmcnt(8)
    v_mfma_f32_32x32x16_bf16 v[144:159], v[208:211], v[44:47], v[144:159]
    v_mfma_f32_32x32x16_bf16 v[160:175], v[212:215], v[44:47], v[160:175]
    buffer_load_dwordx4 v[56:59], v21, s[32:35], s96 offen offset:1024 sc1
    s_add_u32 s48, s53, 16384
    s_add_u32 m0, s50, 6144
    s_nop 0
    buffer_load_dwordx4 v3, s[24:27], s48 offen lds
    ds_read_b64_tr_b16 v[208:209], v13 offset:22528
    ds_read_b64_tr_b16 v[210:211], v13 offset:23552
    ds_read_b64_tr_b16 v[212:213], v13 offset:22784
    ds_read_b64_tr_b16 v[214:215], v13 offset:23808
    s_waitcnt vmcnt(13)
    s_waitcnt lgkmcnt(8)
    v_mfma_f32_32x32x16_bf16 v[144:159], v[192:195], v[76:79], v[144:159]
    v_mfma_f32_32x32x16_bf16 v[160:175], v[196:199], v[76:79], v[160:175]
    buffer_load_dwordx4 v[100:103], v21, s[32:35], s96 offen offset:2048 sc1
    s_barrier
    s_add_u32 s48, s53, 32768
    s_add_u32 m0, s50, 8192
    s_nop 0
    buffer_load_dwordx4 v3, s[24:27], s48 offen lds
    ds_read_b64_tr_b16 v[192:193], v14 offset:0
    ds_read_b64_tr_b16 v[194:195], v14 offset:1024
    ds_read_b64_tr_b16 v[196:197], v14 offset:256
    ds_read_b64_tr_b16 v[198:199], v14 offset:1280
    s_waitcnt vmcnt(14)
    s_waitcnt lgkmcnt(8)
    v_mfma_f32_32x32x16_bf16 v[144:159], v[200:203], v[80:83], v[144:159]
    v_mfma_f32_32x32x16_bf16 v[160:175], v[204:207], v[80:83], v[160:175]
    buffer_load_dwordx4 v[104:107], v21, s[32:35], s96 offen offset:3072 sc1
    s_add_u32 s48, s53, 49152
    s_add_u32 m0, s50, 10240
    s_nop 0
    buffer_load_dwordx4 v3, s[24:27], s48 offen lds
    ds_read_b64_tr_b16 v[200:201], v14 offset:2048
    ds_read_b64_tr_b16 v[202:203], v14 offset:3072
    ds_read_b64_tr_b16 v[204:205], v14 offset:2304
    ds_read_b64_tr_b16 v[206:207], v14 offset:3328
    s_waitcnt vmcnt(14)
    s_waitcnt lgkmcnt(8)
    v_mfma_f32_32x32x16_bf16 v[144:159], v[208:211], v[48:51], v[144:159]
    v_mfma_f32_32x32x16_bf16 v[160:175], v[212:215], v[48:51], v[160:175]
    s_add_u32 s96, s96, 4096
    buffer_load_dwordx4 v[60:63], v21, s[32:35], s96 offen offset:0 sc1
    s_add_u32 s48, s53, 65536
    s_add_u32 m0, s50, 12288
    s_nop 0
    buffer_load_dwordx4 v3, s[24:27], s48 offen lds
    ds_read_b64_tr_b16 v[208:209], v14 offset:4096
    ds_read_b64_tr_b16 v[210:211], v14 offset:5120
    ds_read_b64_tr_b16 v[212:213], v14 offset:4352
    ds_read_b64_tr_b16 v[214:215], v14 offset:5376
    s_waitcnt vmcnt(15)
    s_waitcnt lgkmcnt(8)
    v_mfma_f32_32x32x16_bf16 v[144:159], v[192:195], v[84:87], v[144:159]
    v_mfma_f32_32x32x16_bf16 v[160:175], v[196:199], v[84:87], v[160:175]
    buffer_load_dwordx4 v[108:111], v21, s[32:35], s96 offen offset:1024 sc1
    s_add_u32 s48, s53, 81920
    s_add_u32 m0, s50, 14336
    s_nop 0
    buffer_load_dwordx4 v3, s[24:27], s48 offen lds
    ds_read_b64_tr_b16 v[192:193], v14 offset:6144
    ds_read_b64_tr_b16 v[194:195], v14 offset:7168
    ds_read_b64_tr_b16 v[196:197], v14 offset:6400
    ds_read_b64_tr_b16 v[198:199], v14 offset:7424
    s_waitcnt vmcnt(16)
    s_waitcnt lgkmcnt(8)
    v_mfma_f32_32x32x16_bf16 v[144:159], v[200:203], v[88:91], v[144:159]
    v_mfma_f32_32x32x16_bf16 v[160:175], v[204:207], v[88:91], v[160:175]
    s_add_u32 s48, s53, 98304
    s_add_u32 m0, s50, 16384
    s_nop 0
    buffer_load_dwordx4 v3, s[24:27], s48 offen lds
    s_add_u32 s48, s53, 114688
    s_add_u32 m0, s50, 18432
    s_nop 0
    buffer_load_dwordx4 v3, s[24:27], s48 offen lds
    buffer_load_dwordx2 v[228:229], v17, s[32:35], 0 offen sc1
    s_lshl_b32 s96, s63, 2
    s_add_u32 s96, s96, s55
    s_lshl_b32 s96, s96, 13
    s_add_u32 s96, s96, 5242880
    ds_read_b64_tr_b16 v[200:201], v14 offset:8192
    ds_read_b64_tr_b16 v[202:203], v14 offset:9216
    ds_read_b64_tr_b16 v[204:205], v14 offset:8448
    ds_read_b64_tr_b16 v[206:207], v14 offset:9472
    s_waitcnt vmcnt(18)
    s_waitcnt lgkmcnt(8)
    v_mfma_f32_32x32x16_bf16 v[144:159], v[208:211], v[52:55], v[144:159]
    v_mfma_f32_32x32x16_bf16 v[160:175], v[212:215], v[52:55], v[160:175]
    ds_read_b64_tr_b16 v[208:209], v14 offset:10240
    ds_read_b64_tr_b16 v[210:211], v14 offset:11264
    ds_read_b64_tr_b16 v[212:213], v14 offset:10496
    ds_read_b64_tr_b16 v[214:215], v14 offset:11520
    s_waitcnt vmcnt(16)
    s_waitcnt lgkmcnt(8)
    v_mfma_f32_32x32x16_bf16 v[144:159], v[192:195], v[92:95], v[144:159]
    v_mfma_f32_32x32x16_bf16 v[160:175], v[196:199], v[92:95], v[160:175]
    ds_read_b64_tr_b16 v[192:193], v13 offset:24576
    ds_read_b64_tr_b16 v[194:195], v13 offset:25600
    ds_read_b64_tr_b16 v[196:197], v13 offset:24832
    ds_read_b64_tr_b16 v[198:199], v13 offset:25856
    s_waitcnt vmcnt(14)
    s_waitcnt lgkmcnt(8)
    v_mfma_f32_32x32x16_bf16 v[144:159], v[200:203], v[96:99], v[144:159]
    v_mfma_f32_32x32x16_bf16 v[160:175], v[204:207], v[96:99], v[160:175]
    s_waitcnt vmcnt(0)
    v_cmp_ne_u64 vcc, s[56:57], v[228:229]
    s_nop 1
    s_mov_b32 s101, vcc_lo
    s_cmp_eq_u32 s101, 0
    s_cbranch_scc1 Lo2
    buffer_load_dwordx2 v[228:229], v17, s[32:35], 0 offen sc1
Lo2:
    s_cmp_lg_u32 s101, 0
    s_cbranch_scc1 e_48
    buffer_load_dwordx4 v[32:35], v21, s[32:35], s96 offen offset:0 sc1
    buffer_load_dwordx4 v[64:67], v21, s[32:35], s96 offen offset:1024 sc1
e_48:
    ds_read_b64_tr_b16 v[200:201], v13 offset:26624
    ds_read_b64_tr_b16 v[202:203], v13 offset:27648
    ds_read_b64_tr_b16 v[204:205], v13 offset:26880
    ds_read_b64_tr_b16 v[206:207], v13 offset:27904
    s_waitcnt lgkmcnt(8)
    v_mfma_f32_32x32x16_bf16 v[144:159], v[208:211], v[56:59], v[144:159]
    v_mfma_f32_32x32x16_bf16 v[160:175], v[212:215], v[56:59], v[160:175]
    s_cmp_lg_u32 s101, 0
    s_cbranch_scc1 e_49
    buffer_load_dwordx4 v[36:39], v21, s[32:35], s96 offen offset:2048 sc1
    buffer_load_dwordx4 v[40:43], v21, s[32:35], s96 offen offset:3072 sc1
e_49:
    s_waitcnt lgkmcnt(4)
    v_mfma_f32_32x32x16_bf16 v[144:159], v[192:195], v[100:103], v[144:159]
    v_mfma_f32_32x32x16_bf16 v[160:175], v[196:199], v[100:103], v[160:175]
    s_cmp_lg_u32 s101, 0
    s_cbranch_scc1 e_50
    s_add_u32 s96, s96, 4096
    buffer_load_dwordx4 v[132:135], v21, s[32:35], s96 offen offset:0 sc1
    buffer_load_dwordx4 v[136:139], v21, s[32:35], s96 offen offset:1024 sc1
e_50:
    s_waitcnt lgkmcnt(0)
    v_mfma_f32_32x32x16_bf16 v[144:159], v[200:203], v[104:107], v[144:159]
    v_mfma_f32_32x32x16_bf16 v[160:175], v[204:207], v[104:107], v[160:175]
    s_cmp_lg_u32 s101, 0
    s_cbranch_scc1 e_51
    buffer_load_dwordx4 v[68:71], v21, s[32:35], s96 offen offset:2048 sc1
    buffer_load_dwordx4 v[72:75], v21, s[32:35], s96 offen offset:3072 sc1
e_51:
    s_cmp_eq_u32 s101, 0
    s_cbranch_scc1 Lo3
    s_waitcnt vmcnt(0)
    s_mov_b32 s47, 0x40000
poll_52:
    v_cmp_ne_u64 vcc, s[56:57], v[228:229]
    s_nop 1
    s_and_b32 vcc_lo, vcc_lo, 0xffffffff
    s_cbranch_scc0 pdone_53
    s_sub_u32 s47, s47, 1
    s_cbranch_scc1 pdone_53
    s_sleep 1
    buffer_load_dwordx2 v[228:229], v17, s[32:35], 0 offen sc1
    s_waitcnt vmcnt(0)
    s_branch poll_52
pdone_53:
    buffer_load_dwordx4 v[32:35], v21, s[32:35], s96 offen offset:0 sc1
    buffer_load_dwordx4 v[64:67], v21, s[32:35], s96 offen offset:1024 sc1
    buffer_load_dwordx4 v[36:39], v21, s[32:35], s96 offen offset:2048 sc1
    buffer_load_dwordx4 v[40:43], v21, s[32:35], s96 offen offset:3072 sc1
    s_add_u32 s96, s96, 4096
    buffer_load_dwordx4 v[132:135], v21, s[32:35], s96 offen offset:0 sc1
    buffer_load_dwordx4 v[136:139], v21, s[32:35], s96 offen offset:1024 sc1
    buffer_load_dwordx4 v[68:71], v21, s[32:35], s96 offen offset:2048 sc1
    buffer_load_dwordx4 v[72:75], v21, s[32:35], s96 offen offset:3072 sc1
Lo3:
    s_barrier
    ds_read_b64_tr_b16 v[208:209], v13 offset:0
    ds_read_b64_tr_b16 v[210:211], v13 offset:1024
    ds_read_b64_tr_b16 v[212:213], v13 offset:256
    ds_read_b64_tr_b16 v[214:215], v13 offset:1280
    ds_read_b64_tr_b16 v[192:193], v13 offset:2048
    ds_read_b64_tr_b16 v[194:195], v13 offset:3072
    ds_read_b64_tr_b16 v[196:197], v13 offset:2304
    ds_read_b64_tr_b16 v[198:199], v13 offset:3328
    ds_read_b64_tr_b16 v[200:201], v13 offset:4096
    ds_read_b64_tr_b16 v[202:203], v13 offset:5120
    ds_read_b64_tr_b16 v[204:205], v13 offset:4352
    ds_read_b64_tr_b16 v[206:207], v13 offset:5376
    s_waitcnt lgkmcnt(8)
    v_mfma_f32_32x32x16_bf16 v[144:159], v[208:211], v[60:63], v[144:159]
    v_mfma_f32_32x32x16_bf16 v[160:175], v[212:215], v[60:63], v[160:175]
    ds_read_b64_tr_b16 v[208:209], v13 offset:6144
    ds_read_b64_tr_b16 v[210:211], v13 offset:7168
    ds_read_b64_tr_b16 v[212:213], v13 offset:6400
    ds_read_b64_tr_b16 v[214:215], v13 offset:7424
    s_waitcnt lgkmcnt(8)
    v_mfma_f32_32x32x16_bf16 v[144:159], v[192:195], v[108:111], v[144:159]
    v_mfma_f32_32x32x16_bf16 v[160:175], v[196:199], v[108:111], v[160:175]
    ds_read_b64_tr_b16 v[192:193], v13 offset:8192
    ds_read_b64_tr_b16 v[194:195], v13 offset:9216
    ds_read_b64_tr_b16 v[196:197], v13 offset:8448
    ds_read_b64_tr_b16 v[198:199], v13 offset:9472
    s_waitcnt vmcnt(7)
    s_waitcnt lgkmcnt(8)
    v_mfma_f32_32x32x16_bf16 v[144:159], v[200:203], v[32:35], v[144:159]
    v_mfma_f32_32x32x16_bf16 v[160:175], v[204:207], v[32:35], v[160:175]
    ds_read_b64_tr_b16 v[200:201], v13 offset:10240
    ds_read_b64_tr_b16 v[202:203], v13 offset:11264
    ds_read_b64_tr_b16 v[204:205], v13 offset:10496
    ds_read_b64_tr_b16 v[206:207], v13 offset:11520
    s_waitcnt vmcnt(6)
    s_waitcnt lgkmcnt(8)
    v_mfma_f32_32x32x16_bf16 v[144:159], v[208:211], v[64:67], v[144:159]
    v_mfma_f32_32x32x16_bf16 v[160:175], v[212:215], v[64:67], v[160:175]
    ds_read_b64_tr_b16 v[208:209], v13 offset:12288
    ds_read_b64_tr_b16 v[210:211], v13 offset:13312
    ds_read_b64_tr_b16 v[212:213], v13 offset:12544
    ds_read_b64_tr_b16 v[214:215], v13 offset:13568
    s_waitcnt vmcnt(5)
    s_waitcnt lgkmcnt(8)
    v_mfma_f32_32x32x16_bf16 v[144:159], v[192:195], v[36:39], v[144:159]
    v_mfma_f32_32x32x16_bf16 v[160:175], v[196:199], v[36:39], v[160:175]
    ds_read_b64_tr_b16 v[192:193], v13 offset:14336
    ds_read_b64_tr_b16 v[194:195], v13 offset:15360
    ds_read_b64_tr_b16 v[196:197], v13 offset:14592
    ds_read_b64_tr_b16 v[198:199], v13 offset:15616
    s_waitcnt vmcnt(4)
    s_waitcnt lgkmcnt(8)
    v_mfma_f32_32x32x16_bf16 v[144:159], v[200:203], v[40:43], v[144:159]
    v_mfma_f32_32x32x16_bf16 v[160:175], v[204:207], v[40:43], v[160:175]
    ds_read_b64_tr_b16 v[200:201], v13 offset:16384
    ds_read_b64_tr_b16 v[202:203], v13 offset:17408
    ds_read_b64_tr_b16 v[204:205], v13 offset:16640
    ds_read_b64_tr_b16 v[206:207], v13 offset:17664
    s_waitcnt vmcnt(3)
    s_waitcnt lgkmcnt(8)
    v_mfma_f32_32x32x16_bf16 v[144:159], v[208:211], v[132:135], v[144:159]
    v_mfma_f32_32x32x16_bf16 v[160:175], v[212:215], v[132:135], v[160:175]
    ds_read_b64_tr_b16 v[208:209], v13 offset:18432
    ds_read_b64_tr_b16 v[210:211], v13 offset:19456
    ds_read_b64_tr_b16 v[212:213], v13 offset:18688
    ds_read_b64_tr_b16 v[214:215], v13 offset:19712
    s_waitcnt vmcnt(2)
    s_waitcnt lgkmcnt(8)
    v_mfma_f32_32x32x16_bf16 v[144:159], v[192:195], v[136:139], v[144:159]
    v_mfma_f32_32x32x16_bf16 v[160:175], v[196:199], v[136:139], v[160:175]
    s_waitcnt vmcnt(1)
    s_waitcnt lgkmcnt(4)
    v_mfma_f32_32x32x16_bf16 v[144:159], v[200:203], v[68:71], v[144:159]
    v_mfma_f32_32x32x16_bf16 v[160:175], v[204:207], v[68:71], v[160:175]
    s_waitcnt vmcnt(0)
    s_waitcnt lgkmcnt(0)
    v_mfma_f32_32x32x16_bf16 v[144:159], v[208:211], v[72:75], v[144:159]
    v_mfma_f32_32x32x16_bf16 v[160:175], v[212:215], v[72:75], v[160:175]
    s_mul_i32 s48, s49, 24576
    s_add_u32 s48, s48, 114688
    s_cmp_eq_u32 s55, 0
    s_cbranch_scc1 own_54
    s_sub_u32 s47, s55, 1
    s_and_b32 s47, s47, 3
    s_lshl_b32 s47, s47, 11
    s_add_u32 s47, s47, s48
    v_add_u32 v13, s47, v21
    s_nop 1
    ds_write_b128 v13, v[144:147] offset:0
    ds_write_b128 v13, v[148:151] offset:1024
    s_branch oe_55
own_54:
    s_nop 6
    v_mov_b32 v64, v144
    v_mov_b32 v65, v145
    v_mov_b32 v66, v146
    v_mov_b32 v67, v147
    v_mov_b32 v68, v148
    v_mov_b32 v69, v149
    v_mov_b32 v70, v150
    v_mov_b32 v71, v151
oe_55:
    s_cmp_eq_u32 s55, 1
    s_cbranch_scc1 own_56
    s_sub_u32 s47, s55, 2
    s_and_b32 s47, s47, 3
    s_lshl_b32 s47, s47, 11
    s_add_u32 s47, s47, s48
    v_add_u32 v14, s47, v21
    ds_write_b128 v14, v[152:155] offset:6144
    ds_write_b128 v14, v[156:159] offset:7168
    s_branch oe_57
own_56:
    v_mov_b32 v64, v152
    v_mov_b32 v65, v153
    v_mov_b32 v66, v154
    v_mov_b32 v67, v155
    v_mov_b32 v68, v156
    v_mov_b32 v69, v157
    v_mov_b32 v70, v158
    v_mov_b32 v71, v159
oe_57:
    s_cmp_eq_u32 s55, 2
    s_cbranch_scc1 own_58
    s_sub_u32 s47, s55, 3
    s_and_b32 s47, s47, 3
    s_lshl_b32 s47, s47, 11
    s_add_u32 s47, s47, s48
    v_add_u32 v13, s47, v21
    ds_write_b128 v13, v[160:163] offset:12288
    ds_write_b128 v13, v[164:167] offset:13312
    s_branch oe_59
own_58:
    v_mov_b32 v64, v160
    v_mov_b32 v65, v161
    v_mov_b32 v66, v162
    v_mov_b32 v67, v163
    v_mov_b32 v68, v164
    v_mov_b32 v69, v165
    v_mov_b32 v70, v166
    v_mov_b32 v71, v167
oe_59:
    s_cmp_eq_u32 s55, 3
    s_cbranch_scc1 own_60
    s_sub_u32 s47, s55, 4
    s_and_b32 s47, s47, 3
    s_lshl_b32 s47, s47, 11
    s_add_u32 s47, s47, s48
    v_add_u32 v14, s47, v21
    ds_write_b128 v14, v[168:171] offset:18432
    ds_write_b128 v14, v[172:175] offset:19456
    s_branch oe_61
own_60:
    v_mov_b32 v64, v168
    v_mov_b32 v65, v169
    v_mov_b32 v66, v170
    v_mov_b32 v67, v171
    v_mov_b32 v68, v172
    v_mov_b32 v69, v173
    v_mov_b32 v70, v174
    v_mov_b32 v71, v175
oe_61:
    s_mul_i32 s47, s55, 6144
    s_add_u32 s47, s47, s48
    v_add_u32 v15, s47, v21
    s_waitcnt lgkmcnt(0)
    s_barrier
    ds_read_b128 v[72:75], v15 offset:0
    ds_read_b128 v[76:79], v15 offset:1024
    ds_read_b128 v[80:83], v15 offset:2048
    ds_read_b128 v[84:87], v15 offset:3072
    ds_read_b128 v[88:91], v15 offset:4096
    ds_read_b128 v[92:95], v15 offset:5120
    v_lshlrev_b32 v96, 16, v216
    v_and_b32 v97, 0xffff0000, v216
    v_lshlrev_b32 v98, 16, v217
    v_and_b32 v99, 0xffff0000, v217
    v_lshlrev_b32 v100, 16, v218
    v_and_b32 v101, 0xffff0000, v218
    v_lshlrev_b32 v102, 16, v219
    v_and_b32 v103, 0xffff0000, v219
    s_waitcnt lgkmcnt(4)
    v_add_f32 v64, v64, v72
    v_add_f32 v65, v65, v73
    v_add_f32 v66, v66, v74
    v_add_f32 v67, v67, v75
    v_add_f32 v68, v68, v76
    v_add_f32 v69, v69, v77
    v_add_f32 v70, v70, v78
    v_add_f32 v71, v71, v79
    s_waitcnt lgkmcnt(2)
    v_add_f32 v64, v64, v80
    v_add_f32 v65, v65, v81
    v_add_f32 v66, v66, v82
    v_add_f32 v67, v67, v83
    v_add_f32 v68, v68, v84
    v_add_f32 v69, v69, v85
    v_add_f32 v70, v70, v86
    v_add_f32 v71, v71, v87
    s_waitcnt lgkmcnt(0)
    v_add_f32 v64, v64, v88
    v_add_f32 v65, v65, v89
    v_add_f32 v66, v66, v90
    v_add_f32 v67, v67, v91
    v_add_f32 v68, v68, v92
    v_add_f32 v69, v69, v93
    v_add_f32 v70, v70, v94
    v_add_f32 v71, v71, v95
    v_permlane32_swap_b32 v64, v68
    v_permlane32_swap_b32 v65, v69
    v_permlane32_swap_b32 v66, v70
    v_permlane32_swap_b32 v67, v71
    v_add_f32 v64, v64, v96
    v_add_f32 v65, v65, v97
    v_add_f32 v66, v66, v98
    v_add_f32 v67, v67, v99
    v_add_f32 v68, v68, v100
    v_add_f32 v69, v69, v101
    v_add_f32 v70, v70, v102
    v_add_f32 v71, v71, v103
    v_cvt_pk_bf16_f32 v72, v64, v65
    v_cvt_pk_bf16_f32 v73, v66, v67
    v_cvt_pk_bf16_f32 v74, v68, v69
    v_cvt_pk_bf16_f32 v75, v70, v71
    buffer_store_dwordx4 v[72:75], v10, s[28:31], 0 offen
    s_waitcnt vmcnt(0)
Lend:
    s_endpgm
Lslow:
    ds_read_b128 v[32:35], v10 offset:0
    ds_read_b128 v[64:67], v10 offset:16384
    ds_read_b128 v[36:39], v10 offset:2048
    ds_read_b128 v[40:43], v10 offset:4096
    ds_read_b128 v[44:47], v10 offset:6144
    ds_read_b128 v[48:51], v10 offset:8192
    ds_read_b128 v[52:55], v10 offset:10240
    ds_read_b128 v[56:59], v10 offset:12288
    ds_read_b128 v[60:63], v10 offset:14336
    s_waitcnt lgkmcnt(0)
    v_mfma_f32_32x32x16_bf16 v[188:203], v[64:67], v[28:31], 0
    v_mov_b32 v14, 0xf149f2ca
    ds_read_b128 v[68:71], v11
    ds_read_b128 v[72:75], v11 offset:512
    v_add_u32 v11, v13, v11
    ds_read_b128 v[76:79], v11
    ds_read_b128 v[80:83], v11 offset:512
    v_add_u32 v11, v13, v11
    ds_read_b128 v[84:87], v11
    ds_read_b128 v[88:91], v11 offset:512
    v_add_u32 v11, v13, v11
    ds_read_b128 v[92:95], v11
    ds_read_b128 v[96:99], v11 offset:512
    v_add_u32 v11, v13, v11
    ds_read_b128 v[100:103], v11
    ds_read_b128 v[104:107], v11 offset:512
    v_add_u32 v11, v13, v11
    v_cndmask_b32 v188, v188, v14, s[64:65]
    v_cndmask_b32 v189, v189, v14, s[66:67]
    v_cndmask_b32 v190, v190, v14, s[68:69]
    v_cndmask_b32 v191, v191, v14, s[70:71]
    v_cndmask_b32 v192, v192, v14, s[72:73]
    v_cndmask_b32 v193, v193, v14, s[74:75]
    v_cndmask_b32 v194, v194, v14, s[76:77]
    v_cndmask_b32 v195, v195, v14, s[78:79]
    v_cndmask_b32 v196, v196, v14, s[80:81]
    v_cndmask_b32 v197, v197, v14, s[82:83]
    v_cndmask_b32 v198, v198, v14, s[84:85]
    v_cndmask_b32 v199, v199, v14, s[86:87]
    v_cndmask_b32 v200, v200, v14, s[88:89]
    v_cndmask_b32 v201, v201, v14, s[90:91]
    v_cndmask_b32 v202, v202, v14, s[92:93]
    v_cndmask_b32 v203, v203, v14, s[94:95]
    v_max_f32 v15, v188, v189
    v_max_f32 v18, v190, v191
    v_max3_f32 v15, v192, v193, v15
    v_max3_f32 v18, v194, v195, v18
    v_max3_f32 v15, v196, v197, v15
    v_max3_f32 v18, v198, v199, v18
    v_max3_f32 v15, v200, v201, v15
    v_max3_f32 v18, v202, v203, v18
    s_waitcnt lgkmcnt(0)
    ds_read_b128 v[108:111], v11
    ds_read_b128 v[112:115], v11 offset:512
    v_add_u32 v11, v13, v11
    ds_read_b128 v[116:119], v11
    ds_read_b128 v[120:123], v11 offset:512
    v_add_u32 v11, v13, v11
    ds_read_b128 v[124:127], v11
    ds_read_b128 v[128:131], v11 offset:512
    v_add_u32 v11, v13, v11
    ds_read_b128 v[132:135], v11
    ds_read_b128 v[136:139], v11 offset:512
    s_cmp_eq_u32 s44, 1
    s_cbranch_scc1 d2_62
    s_add_u32 s48, s52, 770048
    s_add_u32 m0, s50, 63488
    s_nop 0
    buffer_load_dwordx4 v3, s[20:23], s48 offen lds
    s_add_u32 s48, s52, 786432
    s_add_u32 m0, s50, 65536
    s_nop 0
    buffer_load_dwordx4 v3, s[20:23], s48 offen lds
d2_62:
    s_cmp_gt_i32 s97, 1
    s_cbranch_scc1 sk_64
    v_mfma_f32_32x32x16_bf16 v[140:155], v[36:39], v[28:31], 0
    s_nop 11
    v_max3_f32 v15, v140, v141, v15
    v_max3_f32 v18, v142, v143, v18
    v_max3_f32 v15, v144, v145, v15
    v_max3_f32 v18, v146, v147, v18
    v_max3_f32 v15, v148, v149, v15
    v_max3_f32 v18, v150, v151, v18
    v_max3_f32 v15, v152, v153, v15
    v_max3_f32 v18, v154, v155, v18
sk_64:
    s_cmp_eq_u32 s44, 1
    s_cbranch_scc1 d2_65
    s_add_u32 s48, s52, 802816
    s_add_u32 m0, s50, 67584
    s_nop 0
    buffer_load_dwordx4 v3, s[20:23], s48 offen lds
    s_add_u32 s48, s52, 819200
    s_add_u32 m0, s50, 69632
    s_nop 0
    buffer_load_dwordx4 v3, s[20:23], s48 offen lds
d2_65:
    s_cmp_gt_i32 s97, 2
    s_cbranch_scc1 sk_67
    v_mfma_f32_32x32x16_bf16 v[140:155], v[40:43], v[28:31], 0
    s_nop 11
    v_max3_f32 v15, v140, v141, v15
    v_max3_f32 v18, v142, v143, v18
    v_max3_f32 v15, v144, v145, v15
    v_max3_f32 v18, v146, v147, v18
    v_max3_f32 v15, v148, v149, v15
    v_max3_f32 v18, v150, v151, v18
    v_max3_f32 v15, v152, v153, v15
    v_max3_f32 v18, v154, v155, v18
sk_67:
    s_cmp_eq_u32 s44, 1
    s_cbranch_scc1 d2_68
    s_add_u32 s48, s52, 835584
    s_add_u32 m0, s50, 71680
    s_nop 0
    buffer_load_dwordx4 v3, s[20:23], s48 offen lds
    s_branch d2e_69
d2_68:
    s_waitcnt vmcnt(0)
    s_mov_b64 exec, 1
    s_add_u32 s47, s62, 16384
    buffer_store_dwordx2 v[24:25], v0, s[32:35], s47 offen sc1
    s_mov_b64 exec, -1
d2e_69:
    s_cmp_gt_i32 s97, 3
    s_cbranch_scc1 sk_70
    v_mfma_f32_32x32x16_bf16 v[140:155], v[44:47], v[28:31], 0
    s_nop 11
    v_max3_f32 v15, v140, v141, v15
    v_max3_f32 v18, v142, v143, v18
    v_max3_f32 v15, v144, v145, v15
    v_max3_f32 v18, v146, v147, v18
    v_max3_f32 v15, v148, v149, v15
    v_max3_f32 v18, v150, v151, v18
    v_max3_f32 v15, v152, v153, v15
    v_max3_f32 v18, v154, v155, v18
sk_70:
    s_cmp_eq_u32 s44, 1
    s_cbranch_scc1 d2_71
    s_add_u32 s48, s52, 851968
    s_add_u32 m0, s50, 73728
    s_nop 0
    buffer_load_dwordx4 v3, s[20:23], s48 offen lds
d2_71:
    s_cmp_gt_i32 s97, 4
    s_cbranch_scc1 sk_73
    v_mfma_f32_32x32x16_bf16 v[140:155], v[48:51], v[28:31], 0
    s_nop 11
    v_max3_f32 v15, v140, v141, v15
    v_max3_f32 v18, v142, v143, v18
    v_max3_f32 v15, v144, v145, v15
    v_max3_f32 v18, v146, v147, v18
    v_max3_f32 v15, v148, v149, v15
    v_max3_f32 v18, v150, v151, v18
    v_max3_f32 v15, v152, v153, v15
    v_max3_f32 v18, v154, v155, v18
sk_73:
    s_cmp_eq_u32 s44, 1
    s_cbranch_scc1 d2_74
    s_add_u32 s48, s52, 868352
    s_add_u32 m0, s50, 75776
    s_nop 0
    buffer_load_dwordx4 v3, s[20:23], s48 offen lds
d2_74:
    s_cmp_gt_i32 s97, 5
    s_cbranch_scc1 sk_76
    v_mfma_f32_32x32x16_bf16 v[140:155], v[52:55], v[28:31], 0
    s_nop 11
    v_max3_f32 v15, v140, v141, v15
    v_max3_f32 v18, v142, v143, v18
    v_max3_f32 v15, v144, v145, v15
    v_max3_f32 v18, v146, v147, v18
    v_max3_f32 v15, v148, v149, v15
    v_max3_f32 v18, v150, v151, v18
    v_max3_f32 v15, v152, v153, v15
    v_max3_f32 v18, v154, v155, v18
sk_76:
    s_cmp_eq_u32 s44, 1
    s_cbranch_scc1 d2_77
    s_add_u32 s48, s52, 884736
    s_add_u32 m0, s50, 77824
    s_nop 0
    buffer_load_dwordx4 v3, s[20:23], s48 offen lds
d2_77:
    s_cmp_gt_i32 s97, 6
    s_cbranch_scc1 sk_79
    v_mfma_f32_32x32x16_bf16 v[140:155], v[56:59], v[28:31], 0
    s_nop 11
    v_max3_f32 v15, v140, v141, v15
    v_max3_f32 v18, v142, v143, v18
    v_max3_f32 v15, v144, v145, v15
    v_max3_f32 v18, v146, v147, v18
    v_max3_f32 v15, v148, v149, v15
    v_max3_f32 v18, v150, v151, v18
    v_max3_f32 v15, v152, v153, v15
    v_max3_f32 v18, v154, v155, v18
sk_79:
    s_cmp_eq_u32 s44, 1
    s_cbranch_scc1 d2_80
    s_add_u32 s48, s52, 901120
    s_add_u32 m0, s50, 79872
    s_nop 0
    buffer_load_dwordx4 v3, s[20:23], s48 offen lds
d2_80:
    s_cmp_gt_i32 s97, 7
    s_cbranch_scc1 sk_82
    v_mfma_f32_32x32x16_bf16 v[140:155], v[60:63], v[28:31], 0
    s_nop 11
    v_max3_f32 v15, v140, v141, v15
    v_max3_f32 v18, v142, v143, v18
    v_max3_f32 v15, v144, v145, v15
    v_max3_f32 v18, v146, v147, v18
    v_max3_f32 v15, v148, v149, v15
    v_max3_f32 v18, v150, v151, v18
    v_max3_f32 v15, v152, v153, v15
    v_max3_f32 v18, v154, v155, v18
sk_82:
    v_max_f32 v15, v15, v18
    v_mov_b32 v18, v15
    s_nop 1
    v_permlane32_swap_b32 v15, v18
    v_max_f32 v15, v15, v18
    v_sub_f32 v204, 0, v15
    v_sub_f32 v205, 0, v15
    v_sub_f32 v206, 0, v15
    v_sub_f32 v207, 0, v15
    v_sub_f32 v208, 0, v15
    v_sub_f32 v209, 0, v15
    v_sub_f32 v210, 0, v15
    v_sub_f32 v211, 0, v15
    v_sub_f32 v212, 0, v15
    v_sub_f32 v213, 0, v15
    v_sub_f32 v214, 0, v15
    v_sub_f32 v215, 0, v15
    v_sub_f32 v216, 0, v15
    v_sub_f32 v217, 0, v15
    v_sub_f32 v218, 0, v15
    v_sub_f32 v219, 0, v15
    s_waitcnt lgkmcnt(0)
    s_barrier
    v_sub_f32 v188, v188, v15
    v_sub_f32 v189, v189, v15
    v_sub_f32 v190, v190, v15
    v_sub_f32 v191, v191, v15
    v_sub_f32 v192, v192, v15
    v_sub_f32 v193, v193, v15
    v_sub_f32 v194, v194, v15
    v_sub_f32 v195, v195, v15
    v_sub_f32 v196, v196, v15
    v_sub_f32 v197, v197, v15
    v_sub_f32 v198, v198, v15
    v_sub_f32 v199, v199, v15
    v_sub_f32 v200, v200, v15
    v_sub_f32 v201, v201, v15
    v_sub_f32 v202, v202, v15
    v_sub_f32 v203, v203, v15
    s_cmp_eq_u32 s44, 1
    s_cbranch_scc1 d2_83
    s_add_u32 s48, s52, 196608
    s_add_u32 m0, s51, 0
    s_nop 0
    buffer_load_dwordx4 v3, s[20:23], s48 offen lds
    s_add_u32 s48, s52, 917504
    s_add_u32 m0, s51, 24576
    s_nop 0
    buffer_load_dwordx4 v3, s[20:23], s48 offen lds
    s_add_u32 s48, s52, 212992
    s_add_u32 m0, s51, 2048
    s_nop 0
    buffer_load_dwordx4 v3, s[20:23], s48 offen lds
    s_add_u32 s48, s52, 933888
    s_add_u32 m0, s51, 26624
    s_nop 0
    buffer_load_dwordx4 v3, s[20:23], s48 offen lds
d2_83:
    v_exp_f32 v188, v188
    v_exp_f32 v189, v189
    v_exp_f32 v190, v190
    v_exp_f32 v191, v191
    v_exp_f32 v192, v192
    v_exp_f32 v193, v193
    v_exp_f32 v194, v194
    v_exp_f32 v195, v195
    v_exp_f32 v196, v196
    v_exp_f32 v197, v197
    v_exp_f32 v198, v198
    v_exp_f32 v199, v199
    v_exp_f32 v200, v200
    v_exp_f32 v201, v201
    v_exp_f32 v202, v202
    v_exp_f32 v203, v203
    v_cvt_pk_bf16_f32 v220, v188, v189
    v_cvt_pk_bf16_f32 v221, v190, v191
    v_cvt_pk_bf16_f32 v222, v192, v193
    v_cvt_pk_bf16_f32 v223, v194, v195
    v_cvt_pk_bf16_f32 v224, v196, v197
    v_cvt_pk_bf16_f32 v225, v198, v199
    v_cvt_pk_bf16_f32 v226, v200, v201
    v_cvt_pk_bf16_f32 v227, v202, v203
    v_mfma_f32_32x32x16_bf16 v[188:203], v[132:135], v[220:223], 0
    s_nop 0
    v_mfma_f32_32x32x16_bf16 v[188:203], v[136:139], v[224:227], v[188:203]
    s_cmp_eq_u32 s44, 1
    s_cbranch_scc1 d2_85
    s_add_u32 s48, s52, 229376
    s_add_u32 m0, s51, 4096
    s_nop 0
    buffer_load_dwordx4 v3, s[20:23], s48 offen lds
    s_add_u32 s48, s52, 950272
    s_add_u32 m0, s51, 28672
    s_nop 0
    buffer_load_dwordx4 v3, s[20:23], s48 offen lds
    s_add_u32 s48, s52, 245760
    s_add_u32 m0, s51, 6144
    s_nop 0
    buffer_load_dwordx4 v3, s[20:23], s48 offen lds
    s_add_u32 s48, s52, 966656
    s_add_u32 m0, s51, 30720
    s_nop 0
    buffer_load_dwordx4 v3, s[20:23], s48 offen lds
d2_85:
    s_cmp_gt_i32 s97, 1
    s_cbranch_scc1 sk_87
    v_mfma_f32_32x32x16_bf16 v[140:155], v[36:39], v[28:31], v[204:219]
    s_nop 11
    v_exp_f32 v140, v140
    v_exp_f32 v141, v141
    v_exp_f32 v142, v142
    v_exp_f32 v143, v143
    v_exp_f32 v144, v144
    v_exp_f32 v145, v145
    v_exp_f32 v146, v146
    v_exp_f32 v147, v147
    v_exp_f32 v148, v148
    v_exp_f32 v149, v149
    v_exp_f32 v150, v150
    v_exp_f32 v151, v151
    v_exp_f32 v152, v152
    v_exp_f32 v153, v153
    v_exp_f32 v154, v154
    v_exp_f32 v155, v155
    v_cvt_pk_bf16_f32 v240, v140, v141
    v_cvt_pk_bf16_f32 v241, v142, v143
    v_cvt_pk_bf16_f32 v242, v144, v145
    v_cvt_pk_bf16_f32 v243, v146, v147
    v_cvt_pk_bf16_f32 v244, v148, v149
    v_cvt_pk_bf16_f32 v245, v150, v151
    v_cvt_pk_bf16_f32 v246, v152, v153
    v_cvt_pk_bf16_f32 v247, v154, v155
    v_mfma_f32_32x32x16_bf16 v[188:203], v[76:79], v[240:243], v[188:203]
    s_nop 0
    v_mfma_f32_32x32x16_bf16 v[188:203], v[80:83], v[244:247], v[188:203]
sk_87:
    s_cmp_eq_u32 s44, 1
    s_cbranch_scc1 d2_88
    s_add_u32 s48, s52, 262144
    s_add_u32 m0, s51, 8192
    s_nop 0
    buffer_load_dwordx4 v3, s[20:23], s48 offen lds
    s_add_u32 s48, s52, 983040
    s_add_u32 m0, s51, 32768
    s_nop 0
    buffer_load_dwordx4 v3, s[20:23], s48 offen lds
    s_add_u32 s48, s52, 278528
    s_add_u32 m0, s51, 10240
    s_nop 0
    buffer_load_dwordx4 v3, s[20:23], s48 offen lds
    s_add_u32 s48, s52, 999424
    s_add_u32 m0, s51, 34816
    s_nop 0
    buffer_load_dwordx4 v3, s[20:23], s48 offen lds
d2_88:
    s_cmp_gt_i32 s97, 2
    s_cbranch_scc1 sk_90
    v_mfma_f32_32x32x16_bf16 v[140:155], v[40:43], v[28:31], v[204:219]
    s_nop 11
    v_exp_f32 v140, v140
    v_exp_f32 v141, v141
    v_exp_f32 v142, v142
    v_exp_f32 v143, v143
    v_exp_f32 v144, v144
    v_exp_f32 v145, v145
    v_exp_f32 v146, v146
    v_exp_f32 v147, v147
    v_exp_f32 v148, v148
    v_exp_f32 v149, v149
    v_exp_f32 v150, v150
    v_exp_f32 v151, v151
    v_exp_f32 v152, v152
    v_exp_f32 v153, v153
    v_exp_f32 v154, v154
    v_exp_f32 v155, v155
    v_cvt_pk_bf16_f32 v240, v140, v141
    v_cvt_pk_bf16_f32 v241, v142, v143
    v_cvt_pk_bf16_f32 v242, v144, v145
    v_cvt_pk_bf16_f32 v243, v146, v147
    v_cvt_pk_bf16_f32 v244, v148, v149
    v_cvt_pk_bf16_f32 v245, v150, v151
    v_cvt_pk_bf16_f32 v246, v152, v153
    v_cvt_pk_bf16_f32 v247, v154, v155
    v_mfma_f32_32x32x16_bf16 v[188:203], v[84:87], v[240:243], v[188:203]
    s_nop 0
    v_mfma_f32_32x32x16_bf16 v[188:203], v[88:91], v[244:247], v[188:203]
sk_90:
    s_cmp_eq_u32 s44, 1
    s_cbranch_scc1 d2_91
    s_add_u32 s48, s52, 294912
    s_add_u32 m0, s50, 24576
    s_nop 0
    buffer_load_dwordx4 v3, s[20:23], s48 offen lds
    s_add_u32 s48, s52, 1015808
    s_add_u32 m0, s50, 81920
    s_nop 0
    buffer_load_dwordx4 v3, s[20:23], s48 offen lds
d2_91:
    s_cmp_gt_i32 s97, 3
    s_cbranch_scc1 sk_93
    v_mfma_f32_32x32x16_bf16 v[140:155], v[44:47], v[28:31], v[204:219]
    s_nop 11
    v_exp_f32 v140, v140
    v_exp_f32 v141, v141
    v_exp_f32 v142, v142
    v_exp_f32 v143, v143
    v_exp_f32 v144, v144
    v_exp_f32 v145, v145
    v_exp_f32 v146, v146
    v_exp_f32 v147, v147
    v_exp_f32 v148, v148
    v_exp_f32 v149, v149
    v_exp_f32 v150, v150
    v_exp_f32 v151, v151
    v_exp_f32 v152, v152
    v_exp_f32 v153, v153
    v_exp_f32 v154, v154
    v_exp_f32 v155, v155
    v_cvt_pk_bf16_f32 v240, v140, v141
    v_cvt_pk_bf16_f32 v241, v142, v143
    v_cvt_pk_bf16_f32 v242, v144, v145
    v_cvt_pk_bf16_f32 v243, v146, v147
    v_cvt_pk_bf16_f32 v244, v148, v149
    v_cvt_pk_bf16_f32 v245, v150, v151
    v_cvt_pk_bf16_f32 v246, v152, v153
    v_cvt_pk_bf16_f32 v247, v154, v155
    v_mfma_f32_32x32x16_bf16 v[188:203], v[92:95], v[240:243], v[188:203]
    s_nop 0
    v_mfma_f32_32x32x16_bf16 v[188:203], v[96:99], v[244:247], v[188:203]
sk_93:
    s_cmp_eq_u32 s44, 1
    s_cbranch_scc1 d2_94
    s_add_u32 s48, s52, 311296
    s_add_u32 m0, s50, 26624
    s_nop 0
    buffer_load_dwordx4 v3, s[20:23], s48 offen lds
    s_add_u32 s48, s52, 1032192
    s_add_u32 m0, s50, 83968
    s_nop 0
    buffer_load_dwordx4 v3, s[20:23], s48 offen lds
d2_94:
    s_cmp_gt_i32 s97, 4
    s_cbranch_scc1 sk_96
    v_mfma_f32_32x32x16_bf16 v[140:155], v[48:51], v[28:31], v[204:219]
    s_nop 11
    v_exp_f32 v140, v140
    v_exp_f32 v141, v141
    v_exp_f32 v142, v142
    v_exp_f32 v143, v143
    v_exp_f32 v144, v144
    v_exp_f32 v145, v145
    v_exp_f32 v146, v146
    v_exp_f32 v147, v147
    v_exp_f32 v148, v148
    v_exp_f32 v149, v149
    v_exp_f32 v150, v150
    v_exp_f32 v151, v151
    v_exp_f32 v152, v152
    v_exp_f32 v153, v153
    v_exp_f32 v154, v154
    v_exp_f32 v155, v155
    v_cvt_pk_bf16_f32 v240, v140, v141
    v_cvt_pk_bf16_f32 v241, v142, v143
    v_cvt_pk_bf16_f32 v242, v144, v145
    v_cvt_pk_bf16_f32 v243, v146, v147
    v_cvt_pk_bf16_f32 v244, v148, v149
    v_cvt_pk_bf16_f32 v245, v150, v151
    v_cvt_pk_bf16_f32 v246, v152, v153
    v_cvt_pk_bf16_f32 v247, v154, v155
    v_mfma_f32_32x32x16_bf16 v[188:203], v[100:103], v[240:243], v[188:203]
    s_nop 0
    v_mfma_f32_32x32x16_bf16 v[188:203], v[104:107], v[244:247], v[188:203]
sk_96:
    s_cmp_gt_i32 s97, 5
    s_cbranch_scc1 sk_97
    v_mfma_f32_32x32x16_bf16 v[140:155], v[52:55], v[28:31], v[204:219]
    s_nop 11
    v_exp_f32 v140, v140
    v_exp_f32 v141, v141
    v_exp_f32 v142, v142
    v_exp_f32 v143, v143
    v_exp_f32 v144, v144
    v_exp_f32 v145, v145
    v_exp_f32 v146, v146
    v_exp_f32 v147, v147
    v_exp_f32 v148, v148
    v_exp_f32 v149, v149
    v_exp_f32 v150, v150
    v_exp_f32 v151, v151
    v_exp_f32 v152, v152
    v_exp_f32 v153, v153
    v_exp_f32 v154, v154
    v_exp_f32 v155, v155
    v_cvt_pk_bf16_f32 v240, v140, v141
    v_cvt_pk_bf16_f32 v241, v142, v143
    v_cvt_pk_bf16_f32 v242, v144, v145
    v_cvt_pk_bf16_f32 v243, v146, v147
    v_cvt_pk_bf16_f32 v244, v148, v149
    v_cvt_pk_bf16_f32 v245, v150, v151
    v_cvt_pk_bf16_f32 v246, v152, v153
    v_cvt_pk_bf16_f32 v247, v154, v155
    v_mfma_f32_32x32x16_bf16 v[188:203], v[108:111], v[240:243], v[188:203]
    s_nop 0
    v_mfma_f32_32x32x16_bf16 v[188:203], v[112:115], v[244:247], v[188:203]
sk_97:
    s_cmp_gt_i32 s97, 6
    s_cbranch_scc1 sk_98
    v_mfma_f32_32x32x16_bf16 v[140:155], v[56:59], v[28:31], v[204:219]
    s_nop 11
    v_exp_f32 v140, v140
    v_exp_f32 v141, v141
    v_exp_f32 v142, v142
    v_exp_f32 v143, v143
    v_exp_f32 v144, v144
    v_exp_f32 v145, v145
    v_exp_f32 v146, v146
    v_exp_f32 v147, v147
    v_exp_f32 v148, v148
    v_exp_f32 v149, v149
    v_exp_f32 v150, v150
    v_exp_f32 v151, v151
    v_exp_f32 v152, v152
    v_exp_f32 v153, v153
    v_exp_f32 v154, v154
    v_exp_f32 v155, v155
    v_cvt_pk_bf16_f32 v240, v140, v141
    v_cvt_pk_bf16_f32 v241, v142, v143
    v_cvt_pk_bf16_f32 v242, v144, v145
    v_cvt_pk_bf16_f32 v243, v146, v147
    v_cvt_pk_bf16_f32 v244, v148, v149
    v_cvt_pk_bf16_f32 v245, v150, v151
    v_cvt_pk_bf16_f32 v246, v152, v153
    v_cvt_pk_bf16_f32 v247, v154, v155
    v_mfma_f32_32x32x16_bf16 v[188:203], v[116:119], v[240:243], v[188:203]
    s_nop 0
    v_mfma_f32_32x32x16_bf16 v[188:203], v[120:123], v[244:247], v[188:203]
sk_98:
    s_cmp_gt_i32 s97, 7
    s_cbranch_scc1 sk_99
    v_mfma_f32_32x32x16_bf16 v[140:155], v[60:63], v[28:31], v[204:219]
    s_nop 11
    v_exp_f32 v140, v140
    v_exp_f32 v141, v141
    v_exp_f32 v142, v142
    v_exp_f32 v143, v143
    v_exp_f32 v144, v144
    v_exp_f32 v145, v145
    v_exp_f32 v146, v146
    v_exp_f32 v147, v147
    v_exp_f32 v148, v148
    v_exp_f32 v149, v149
    v_exp_f32 v150, v150
    v_exp_f32 v151, v151
    v_exp_f32 v152, v152
    v_exp_f32 v153, v153
    v_exp_f32 v154, v154
    v_exp_f32 v155, v155
    v_cvt_pk_bf16_f32 v240, v140, v141
    v_cvt_pk_bf16_f32 v241, v142, v143
    v_cvt_pk_bf16_f32 v242, v144, v145
    v_cvt_pk_bf16_f32 v243, v146, v147
    v_cvt_pk_bf16_f32 v244, v148, v149
    v_cvt_pk_bf16_f32 v245, v150, v151
    v_cvt_pk_bf16_f32 v246, v152, v153
    v_cvt_pk_bf16_f32 v247, v154, v155
    v_mfma_f32_32x32x16_bf16 v[188:203], v[124:127], v[240:243], v[188:203]
    s_nop 0
    v_mfma_f32_32x32x16_bf16 v[188:203], v[128:131], v[244:247], v[188:203]
sk_99:
    s_mov_b32 s101, 1
    buffer_load_dwordx2 v[228:229], v16, s[32:35], 0 offen sc1
    s_nop 7
    s_nop 7
    s_nop 7
    s_branch Lattd
.section .rodata,"a"
.p2align 6
.amdhsa_kernel parallel_sum__sliding_block__dense_activation_silu__prompt_kernel
  .amdhsa_next_free_vgpr 256
  .amdhsa_next_free_sgpr 102
  .amdhsa_accum_offset 256
  .amdhsa_group_segment_fixed_size 0
  .amdhsa_kernarg_size 72
  .amdhsa_user_sgpr_count 2
  .amdhsa_user_sgpr_kernarg_segment_ptr 1
  .amdhsa_system_sgpr_workgroup_id_x 1
.end_amdhsa_kernel
```
